```python
import torch

def _softmax(x, axis=-1):
    return torch.softmax(x, dim=axis)
def _gelu(x):
    return torch.nn.functional.gelu(x, approximate="tanh")
def _silu(x):
    return torch.nn.functional.silu(x)
def _sigmoid(x):
    return torch.sigmoid(x)
def _layernorm(x, axis=-1, eps=1e-5):
    m = x.mean(dim=axis, keepdim=True)
    v = x.var(dim=axis, keepdim=True, unbiased=False)
    return (x - m) / torch.sqrt(v + eps)
def _scatter_add(tgt, idx, src, axis=0):
    return tgt.clone().index_add_(axis, idx, src)
def _segment_sum(src, seg, n):
    out = torch.zeros((n,) + src.shape[1:], dtype=src.dtype)
    return out.index_add_(0, seg, src)
def _pad(x, pw):
    flat = tuple(v for pair in reversed(pw) for v in pair)
    return torch.nn.functional.pad(x, flat)

kernel_name = 'recurrent_scan__sliding_block_cached__geglu_ffn__decode'

def setup_inputs():

    _w = (lambda a: (lambda t: t.to(torch.bfloat16) if t.is_floating_point() else t)(torch.as_tensor(a)))
    def _A_setup():
        B, Sq, D = 2, 1, 448
        Hq, Hkv, Sk, Dh = 16, 8, 32768, 256
        assert Hq % Hkv == 0, (Hq, Hkv)
        return {
            "x": _w((lambda *s: torch.randn(*s, dtype=torch.bfloat16) * 0.05)(B, Sq, D)),
            "k_cache": _w((lambda *s: torch.randn(*s, dtype=torch.bfloat16) * 1.6)(B, Hkv, Sk, Dh)),
            "v_cache": _w((lambda *s: torch.randn(*s, dtype=torch.bfloat16) * 0.2)(B, Hkv, Sk, Dh)),
            "wq": _w((lambda *s: torch.randn(*s, dtype=torch.bfloat16) * 1.6)(D, Hq * Dh) * (D ** -0.5)),
            "wo": _w((lambda *s: torch.randn(*s, dtype=torch.bfloat16) * 0.2)(Hq * Dh, D) * ((Hq * Dh) ** -0.5)),
        }
    _A_in = _A_setup()

    def _B_setup():
        B, S, D, F = 2, 1, 448, 1792
        return {
            "x": _w((lambda *s: torch.randn(*s, dtype=torch.bfloat16) * 0.05)(B, S, D)),
            "w_gate": _w((lambda *s: torch.randn(*s, dtype=torch.bfloat16) * 0.1)(D, F)),
            "w_up": _w((lambda *s: torch.randn(*s, dtype=torch.bfloat16) * 0.1)(D, F)),
            "w_down": _w((lambda *s: torch.randn(*s, dtype=torch.bfloat16) * 0.1)(F, D)),
        }
    _B_in = _B_setup()

    return {
        "A_x": _A_in["x"],
        "A_k_cache": _A_in["k_cache"],
        "A_v_cache": _A_in["v_cache"],
        "A_wq": _A_in["wq"],
        "A_wo": _A_in["wo"],
        "B_x": _B_in["x"],
        "B_w_gate": _B_in["w_gate"],
        "B_w_up": _B_in["w_up"],
        "B_w_down": _B_in["w_down"],
    }

def reference(A_x, A_k_cache, A_v_cache, A_wq, A_wo, B_x, B_w_gate, B_w_up, B_w_down):
    def _A_ref(x, k_cache, v_cache, wq, wo):
        B, Sq, D = x.shape
        Hq, Dh = 16, 256
        Hkv, Sk = k_cache.shape[1], k_cache.shape[2]
        W = min(4096, max(256, Sk // 4))
        rep = Hq // Hkv
        q = (lambda x, *d: x.permute(*d))((x @ wq).reshape(B, Sq, Hq, Dh), 0, 2, 1, 3)
        k = (lambda x, n, axis: torch.repeat_interleave(x, n, dim=axis))(k_cache[:, :, Sk - W:, :], rep, axis=1)
        v = (lambda x, n, axis: torch.repeat_interleave(x, n, dim=axis))(v_cache[:, :, Sk - W:, :], rep, axis=1)
        scores = torch.einsum("bhqd,bhkd->bhqk", q, k) * (Dh ** -0.5)
        p = _softmax(scores, axis=-1)
        o = torch.einsum("bhqk,bhkd->bhqd", p, v)
        return (lambda x, *d: x.permute(*d))(o, 0, 2, 1, 3).reshape(B, Sq, Hq * Dh) @ wo

    def _B_ref(x, w_gate, w_up, w_down):
        return (_gelu(x @ w_gate) * (x @ w_up)) @ w_down

    x = A_x
    xn = _layernorm(x, axis=-1)
    s = _A_ref(xn, A_k_cache, A_v_cache, A_wq, A_wo)
    g = _silu(_B_ref(xn, B_w_gate, B_w_up, B_w_down))
    return x + s * g
```

```asm
; @launch grid=(256,1,1) block=(1024,1,1) lds=40000
.amdgcn_target "amdgcn-amd-amdhsa--gfx950"
.text
.globl recurrent_scan__sliding_block_cached__geglu_ffn__decode_kernel
.p2align 8
.type recurrent_scan__sliding_block_cached__geglu_ffn__decode_kernel,@function
recurrent_scan__sliding_block_cached__geglu_ffn__decode_kernel:
s_cmp_ge_u32 s2, 256
s_cbranch_scc1 L_end
s_load_dwordx16 s[4:19], s[0:1], 0
s_load_dwordx8 s[20:27], s[0:1], 64
v_lshrrev_b32 v1, 6, v0
v_and_b32 v0, 63, v0
v_lshlrev_b32 v2, 1, v0
v_mov_b32 v3, 0
v_readfirstlane_b32 s3, v1
v_and_b32 v2, 0x7c, v2
ds_write_b32 v2, v3
s_cmp_lt_u32 s3, 2
s_cbranch_scc0 L_dpro
s_setprio 3
s_and_b32 s60, s2, 7
s_lshr_b32 s61, s2, 3
s_lshr_b32 s62, s61, 4
s_and_b32 s63, s61, 15
s_cmp_eq_u32 s3, 0
s_cbranch_scc0 L_ctrl1
s_lshr_b32 s74, s61, 3
s_and_b32 s75, s61, 7
s_mul_i32 s96, s74, 917504
s_lshl_b32 s97, s60, 10
s_add_u32 s96, s96, s97
s_lshl_b32 s97, s75, 7
s_add_u32 s96, s96, s97
s_lshl_b32 s98, s60, 3
s_add_u32 s98, s98, s74
s_lshl_b32 s98, s98, 11
s_lshl_b32 s99, s75, 8
s_add_u32 s98, s98, s99
s_add_u32 s98, s98, 4096
s_mov_b32 s99, 8192
s_mov_b32 s97, 8192
s_mov_b32 s42, 0x380000
s_waitcnt lgkmcnt(0)
s_mov_b32 s40, s10
s_mov_b32 s41, s11
s_branch L_tile
L_ctrl1:
s_lshr_b32 s47, s2, 1
s_and_b32 s75, s2, 1
s_lshl_b32 s75, s75, 7
s_add_u32 s47, s47, s75
s_cmp_lt_u32 s47, 224
s_cbranch_scc0 L_notile
s_lshr_b32 s75, s47, 1
s_mul_i32 s74, s75, 4682
s_lshr_b32 s74, s74, 17
s_mul_i32 s96, s74, 28
s_sub_u32 s75, s75, s96
s_mul_i32 s96, s74, 401408
s_lshl_b32 s97, s75, 7
s_add_u32 s96, s96, s97
s_and_b32 s99, s47, 1
s_lshl_b32 s98, s99, 2
s_add_u32 s98, s98, s74
s_mul_i32 s98, s98, 14336
s_lshl_b32 s97, s75, 8
s_add_u32 s98, s98, s97
s_add_u32 s98, s98, 135168
s_mov_b32 s42, 0x188000
s_cmp_eq_u32 s99, 0
s_waitcnt lgkmcnt(0)
s_cselect_b32 s40, s16, s18
s_cselect_b32 s41, s17, s19
s_mov_b32 s97, 3584
s_mov_b32 s99, 7168
L_tile:
s_mov_b32 s43, 0x20000
s_mov_b32 s52, s4
s_mov_b32 s53, s5
s_mov_b32 s54, 0x700
s_mov_b32 s55, 0x20000
v_lshrrev_b32 v4, 3, v0
v_mul_lo_u32 v4, s97, v4
v_and_b32 v5, 7, v0
v_lshlrev_b32 v5, 4, v5
v_add_u32 v4, v4, v5
v_and_b32 v6, 31, v0
v_lshrrev_b32 v7, 5, v0
v_mul_u32_u24 v7, 896, v7
v_lshlrev_b32 v5, 5, v6
v_add_u32 v5, v5, v7
v_cmp_gt_u32 vcc, 28, v6
v_mov_b32 v7, 0x10000
s_nop 0
v_cndmask_b32 v5, v7, v5, vcc
buffer_load_dwordx4 v[20:23], v5, s[52:55], 0 offen
buffer_load_dwordx4 v[24:27], v5, s[52:55], 0 offen offset:16
s_mul_i32 s75, s74, 224
v_lshlrev_b32 v6, 2, v0
v_cmp_gt_u32 vcc, 56, v0
s_nop 1
v_cndmask_b32 v6, v7, v6, vcc
buffer_load_dword v28, v6, s[52:55], s75 offen
buffer_load_dword v29, v6, s[52:55], s75 offen offset:896
s_lshl_b32 s97, s97, 3
buffer_load_dwordx4 v[40:43], v4, s[40:43], s96 offen nt
s_add_u32 s96, s96, s97
buffer_load_dwordx4 v[44:47], v4, s[40:43], s96 offen nt
s_add_u32 s96, s96, s97
buffer_load_dwordx4 v[48:51], v4, s[40:43], s96 offen nt
s_add_u32 s96, s96, s97
buffer_load_dwordx4 v[52:55], v4, s[40:43], s96 offen nt
s_add_u32 s96, s96, s97
buffer_load_dwordx4 v[56:59], v4, s[40:43], s96 offen nt
s_add_u32 s96, s96, s97
buffer_load_dwordx4 v[60:63], v4, s[40:43], s96 offen nt
s_add_u32 s96, s96, s97
buffer_load_dwordx4 v[64:67], v4, s[40:43], s96 offen nt
s_add_u32 s96, s96, s97
buffer_load_dwordx4 v[68:71], v4, s[40:43], s96 offen nt
s_add_u32 s96, s96, s97
buffer_load_dwordx4 v[72:75], v4, s[40:43], s96 offen nt
s_add_u32 s96, s96, s97
buffer_load_dwordx4 v[76:79], v4, s[40:43], s96 offen nt
s_add_u32 s96, s96, s97
buffer_load_dwordx4 v[80:83], v4, s[40:43], s96 offen nt
s_add_u32 s96, s96, s97
buffer_load_dwordx4 v[84:87], v4, s[40:43], s96 offen nt
s_add_u32 s96, s96, s97
buffer_load_dwordx4 v[88:91], v4, s[40:43], s96 offen nt
s_add_u32 s96, s96, s97
buffer_load_dwordx4 v[92:95], v4, s[40:43], s96 offen nt
s_load_dwordx2 s[68:69], s[26:27], 0
s_barrier
s_mov_b32 s48, s24
s_mov_b32 s49, s25
s_mov_b32 s50, 0x100
s_mov_b32 s51, 0x20000
s_getreg_b32 s46, hwreg(HW_REG_XCC_ID)
s_and_b32 s46, s46, 15
s_or_b32 s46, s46, 0x80
s_lshl_b32 s47, s60, 5
s_cmp_eq_u32 s3, 1
s_cbranch_scc0 L_nocen
v_mov_b32 v5, s46
v_mov_b32 v7, s61
s_mov_b64 exec, 1
buffer_store_byte v5, v7, s[48:51], s47 offen
s_mov_b64 exec, -1
L_nocen:
s_mov_b32 s36, s26
s_mov_b32 s37, s27
s_mov_b32 s38, 0x40000000
s_mov_b32 s39, 0x20000
s_mov_b32 s28, s6
s_mov_b32 s29, s7
s_mov_b32 s30, 0x10000000
s_mov_b32 s31, 0x20000
s_mov_b32 s32, s8
s_mov_b32 s33, s9
s_mov_b32 s34, 0x10000000
s_mov_b32 s35, 0x20000
s_mov_b32 s56, s22
s_mov_b32 s57, s23
s_mov_b32 s58, 0x700
s_mov_b32 s59, 0x20000
v_and_b32 v4, 8, v0
v_cmp_ne_u32 s[70:71], 0, v4
v_cmp_gt_u32 s[72:73], 32, v0
v_and_b32 v4, 7, v0
v_and_b32 v5, 1, v0
v_cmp_eq_u32 vcc, 1, v5
v_mov_b32 v6, 0xffff
v_mov_b32 v7, 0xffff0000
v_cndmask_b32 v6, v6, v7, vcc
v_lshrrev_b32 v4, 1, v4
v_cmp_eq_u32 vcc, 0, v4
s_nop 1
v_cndmask_b32 v8, 0, v6, vcc
v_cmp_eq_u32 vcc, 1, v4
s_nop 1
v_cndmask_b32 v9, 0, v6, vcc
v_cmp_eq_u32 vcc, 2, v4
s_nop 1
v_cndmask_b32 v10, 0, v6, vcc
v_cmp_eq_u32 vcc, 3, v4
s_nop 1
v_cndmask_b32 v11, 0, v6, vcc
v_lshrrev_b32 v4, 4, v0
v_lshlrev_b32 v4, 9, v4
v_and_b32 v5, 15, v0
v_lshlrev_b32 v5, 4, v5
v_add_u32 v1, v4, v5
s_mov_b32 s74, s3
s_add_u32 s74, s74, s63
s_and_b32 s74, s74, 15
s_lshl_b32 s75, s62, 3
s_add_u32 s75, s75, s60
s_lshl_b32 s75, s75, 24
s_add_u32 s75, s75, 0xE00000
s_lshl_b32 s46, s63, 17
s_add_u32 s75, s75, s46
s_lshl_b32 s74, s74, 13
s_add_u32 s44, s74, s75
s_add_u32 s45, s44, 4096
s_waitcnt lgkmcnt(0)
s_add_u32 s68, s68, 1
s_addc_u32 s69, s69, 0
s_mul_i32 s96, s68, 0x7f4a7c15
s_mul_hi_u32 s97, s68, 0x7f4a7c15
s_mul_i32 s75, s68, 0x9e3779b9
s_add_u32 s97, s97, s75
s_mul_i32 s75, s69, 0x7f4a7c15
s_add_u32 s97, s97, s75
s_and_b32 s64, s96, 0xfff
s_bfe_u32 s65, s96, 0xc000c
s_lshr_b32 s66, s96, 24
s_lshl_b32 s75, s97, 8
s_or_b32 s66, s66, s75
s_and_b32 s66, s66, 0xfff
s_bfe_u32 s67, s97, 0xc0004
s_mov_b32 s74, 0x3f803f80
s_lshl_b32 s47, s60, 5
v_and_b32 v5, 31, v0
buffer_load_ubyte v36, v5, s[48:51], s47 offen sc1
s_waitcnt vmcnt(17)
v_dot2_f32_bf16 v30, v20, s74, 0
v_dot2_f32_bf16 v31, v20, v20, 0
s_nop 1
v_dot2c_f32_bf16 v30, s74, v21
v_dot2c_f32_bf16 v31, v21, v21
v_dot2c_f32_bf16 v30, s74, v22
v_dot2c_f32_bf16 v31, v22, v22
v_dot2c_f32_bf16 v30, s74, v23
v_dot2c_f32_bf16 v31, v23, v23
v_dot2c_f32_bf16 v30, s74, v24
v_dot2c_f32_bf16 v31, v24, v24
v_dot2c_f32_bf16 v30, s74, v25
v_dot2c_f32_bf16 v31, v25, v25
v_dot2c_f32_bf16 v30, s74, v26
v_dot2c_f32_bf16 v31, v26, v26
v_dot2c_f32_bf16 v30, s74, v27
v_dot2c_f32_bf16 v31, v27, v27
s_nop 1
v_add_f32_dpp v30, v30, v30 row_ror:8 row_mask:0xf bank_mask:0xf
v_add_f32_dpp v31, v31, v31 row_ror:8 row_mask:0xf bank_mask:0xf
s_nop 0
v_add_f32_dpp v30, v30, v30 row_ror:4 row_mask:0xf bank_mask:0xf
v_add_f32_dpp v31, v31, v31 row_ror:4 row_mask:0xf bank_mask:0xf
s_nop 0
v_add_f32_dpp v30, v30, v30 row_ror:2 row_mask:0xf bank_mask:0xf
v_add_f32_dpp v31, v31, v31 row_ror:2 row_mask:0xf bank_mask:0xf
s_nop 0
v_add_f32_dpp v30, v30, v30 row_ror:1 row_mask:0xf bank_mask:0xf
v_add_f32_dpp v31, v31, v31 row_ror:1 row_mask:0xf bank_mask:0xf
v_mov_b32 v32, v30
v_mov_b32 v33, v31
s_nop 0
v_permlane16_swap_b32 v30, v32
v_permlane16_swap_b32 v31, v33
v_add_f32 v30, v30, v32
v_add_f32 v31, v31, v33
v_mul_f32 v30, 0x3b124925, v30
v_mul_f32 v31, 0x3b124925, v31
v_fma_f32 v31, -v30, v30, v31
v_max_f32 v31, 0, v31
v_cvt_pk_bf16_f32 v31, v31, v30
v_and_b32 v30, 0xffff0000, v31
v_lshlrev_b32 v31, 16, v31
v_add_f32 v31, 0x3727c5ac, v31
v_cvt_pk_bf16_f32 v31, v31, v31
v_and_b32 v31, 0xffff0000, v31
v_sqrt_f32 v31, v31
s_nop 0
v_cvt_pk_bf16_f32 v31, v31, v31
v_and_b32 v31, 0xffff0000, v31
v_rcp_f32 v31, v31
v_readlane_b32 s74, v30, 0
v_readlane_b32 s75, v30, 32
v_readlane_b32 s96, v31, 0
v_readlane_b32 s97, v31, 32
s_waitcnt vmcnt(15)
v_lshlrev_b32 v96, 16, v28
v_and_b32 v97, 0xffff0000, v28
v_lshlrev_b32 v98, 16, v29
v_and_b32 v99, 0xffff0000, v29
v_subrev_f32 v96, s74, v96
v_subrev_f32 v97, s74, v97
v_subrev_f32 v98, s75, v98
v_subrev_f32 v99, s75, v99
v_cvt_pk_bf16_f32 v100, v96, v97
v_cvt_pk_bf16_f32 v101, v98, v99
v_lshlrev_b32 v96, 16, v100
v_and_b32 v97, 0xffff0000, v100
v_lshlrev_b32 v98, 16, v101
v_and_b32 v99, 0xffff0000, v101
v_mul_f32 v96, s96, v96
v_mul_f32 v97, s96, v97
v_mul_f32 v98, s97, v98
v_mul_f32 v99, s97, v99
v_cvt_pk_bf16_f32 v96, v96, v96
v_cvt_pk_bf16_f32 v97, v97, v97
v_cvt_pk_bf16_f32 v98, v98, v98
v_cvt_pk_bf16_f32 v99, v99, v99
s_mul_i32 s74, s3, 896
v_lshlrev_b32 v6, 3, v0
v_add_u32 v6, s74, v6
v_cmp_gt_u32 vcc, 56, v0
s_nop 0
s_and_saveexec_b64 s[96:97], vcc
ds_write_b64 v6, v[96:97] offset:1216
ds_write_b64 v6, v[98:99] offset:1664
s_mov_b64 exec, s[96:97]
v_lshrrev_b32 v6, 3, v0
v_lshlrev_b32 v6, 2, v6
v_add_u32 v6, s74, v6
s_waitcnt lgkmcnt(0)
ds_read_b32 v96, v6 offset:1216
ds_read_b32 v97, v6 offset:1664
ds_read_b32 v98, v6 offset:1248
ds_read_b32 v99, v6 offset:1696
ds_read_b32 v100, v6 offset:1280
ds_read_b32 v101, v6 offset:1728
ds_read_b32 v102, v6 offset:1312
ds_read_b32 v103, v6 offset:1760
ds_read_b32 v104, v6 offset:1344
ds_read_b32 v105, v6 offset:1792
ds_read_b32 v106, v6 offset:1376
ds_read_b32 v107, v6 offset:1824
ds_read_b32 v108, v6 offset:1408
ds_read_b32 v109, v6 offset:1856
v_lshrrev_b32 v4, 5, v0
v_mul_lo_u32 v4, s99, v4
v_and_b32 v5, 7, v0
v_lshlrev_b32 v5, 5, v5
v_bfe_u32 v7, v0, 4, 1
v_lshlrev_b32 v7, 4, v7
v_add3_u32 v4, v4, v5, v7
s_waitcnt lgkmcnt(0)
ds_read_b32 v110, v6 offset:1440
ds_read_b32 v111, v6 offset:1888
ds_read_b32 v112, v6 offset:1472
ds_read_b32 v113, v6 offset:1920
ds_read_b32 v114, v6 offset:1504
ds_read_b32 v115, v6 offset:1952
ds_read_b32 v116, v6 offset:1536
ds_read_b32 v117, v6 offset:1984
ds_read_b32 v118, v6 offset:1568
ds_read_b32 v119, v6 offset:2016
ds_read_b32 v120, v6 offset:1600
ds_read_b32 v121, v6 offset:2048
ds_read_b32 v122, v6 offset:1632
ds_read_b32 v123, v6 offset:2080
v_and_b32 v20, v96, v8
v_and_b32 v21, v96, v9
v_and_b32 v22, v96, v10
v_and_b32 v23, v96, v11
v_and_b32 v24, v97, v8
v_and_b32 v25, v97, v9
v_and_b32 v26, v97, v10
v_and_b32 v27, v97, v11
s_waitcnt vmcnt(14)
v_mfma_f32_16x16x32_bf16 v[12:15], v[20:23], v[40:43], 0
v_mfma_f32_16x16x32_bf16 v[16:19], v[24:27], v[40:43], 0
v_and_b32 v28, v98, v8
v_and_b32 v29, v98, v9
v_and_b32 v30, v98, v10
v_and_b32 v31, v98, v11
v_and_b32 v32, v99, v8
v_and_b32 v33, v99, v9
v_and_b32 v34, v99, v10
v_and_b32 v35, v99, v11
s_waitcnt vmcnt(13)
v_mfma_f32_16x16x32_bf16 v[12:15], v[28:31], v[44:47], v[12:15]
v_mfma_f32_16x16x32_bf16 v[16:19], v[32:35], v[44:47], v[16:19]
v_and_b32 v20, v100, v8
v_and_b32 v21, v100, v9
v_and_b32 v22, v100, v10
v_and_b32 v23, v100, v11
v_and_b32 v24, v101, v8
v_and_b32 v25, v101, v9
v_and_b32 v26, v101, v10
v_and_b32 v27, v101, v11
s_waitcnt vmcnt(12)
v_mfma_f32_16x16x32_bf16 v[12:15], v[20:23], v[48:51], v[12:15]
v_mfma_f32_16x16x32_bf16 v[16:19], v[24:27], v[48:51], v[16:19]
v_and_b32 v28, v102, v8
v_and_b32 v29, v102, v9
v_and_b32 v30, v102, v10
v_and_b32 v31, v102, v11
v_and_b32 v32, v103, v8
v_and_b32 v33, v103, v9
v_and_b32 v34, v103, v10
v_and_b32 v35, v103, v11
s_waitcnt vmcnt(11)
v_mfma_f32_16x16x32_bf16 v[12:15], v[28:31], v[52:55], v[12:15]
v_mfma_f32_16x16x32_bf16 v[16:19], v[32:35], v[52:55], v[16:19]
v_and_b32 v20, v104, v8
v_and_b32 v21, v104, v9
v_and_b32 v22, v104, v10
v_and_b32 v23, v104, v11
v_and_b32 v24, v105, v8
v_and_b32 v25, v105, v9
v_and_b32 v26, v105, v10
v_and_b32 v27, v105, v11
s_waitcnt vmcnt(10)
v_mfma_f32_16x16x32_bf16 v[12:15], v[20:23], v[56:59], v[12:15]
v_mfma_f32_16x16x32_bf16 v[16:19], v[24:27], v[56:59], v[16:19]
v_and_b32 v28, v106, v8
v_and_b32 v29, v106, v9
v_and_b32 v30, v106, v10
v_and_b32 v31, v106, v11
v_and_b32 v32, v107, v8
v_and_b32 v33, v107, v9
v_and_b32 v34, v107, v10
v_and_b32 v35, v107, v11
s_waitcnt vmcnt(9)
v_mfma_f32_16x16x32_bf16 v[12:15], v[28:31], v[60:63], v[12:15]
v_mfma_f32_16x16x32_bf16 v[16:19], v[32:35], v[60:63], v[16:19]
v_and_b32 v20, v108, v8
v_and_b32 v21, v108, v9
v_and_b32 v22, v108, v10
v_and_b32 v23, v108, v11
v_and_b32 v24, v109, v8
v_and_b32 v25, v109, v9
v_and_b32 v26, v109, v10
v_and_b32 v27, v109, v11
s_waitcnt vmcnt(8)
v_mfma_f32_16x16x32_bf16 v[12:15], v[20:23], v[64:67], v[12:15]
v_mfma_f32_16x16x32_bf16 v[16:19], v[24:27], v[64:67], v[16:19]
s_waitcnt lgkmcnt(0)
v_and_b32 v28, v110, v8
v_and_b32 v29, v110, v9
v_and_b32 v30, v110, v10
v_and_b32 v31, v110, v11
v_and_b32 v32, v111, v8
v_and_b32 v33, v111, v9
v_and_b32 v34, v111, v10
v_and_b32 v35, v111, v11
s_waitcnt vmcnt(7)
v_mfma_f32_16x16x32_bf16 v[12:15], v[28:31], v[68:71], v[12:15]
v_mfma_f32_16x16x32_bf16 v[16:19], v[32:35], v[68:71], v[16:19]
v_and_b32 v20, v112, v8
v_and_b32 v21, v112, v9
v_and_b32 v22, v112, v10
v_and_b32 v23, v112, v11
v_and_b32 v24, v113, v8
v_and_b32 v25, v113, v9
v_and_b32 v26, v113, v10
v_and_b32 v27, v113, v11
s_waitcnt vmcnt(6)
v_mfma_f32_16x16x32_bf16 v[12:15], v[20:23], v[72:75], v[12:15]
v_mfma_f32_16x16x32_bf16 v[16:19], v[24:27], v[72:75], v[16:19]
v_and_b32 v28, v114, v8
v_and_b32 v29, v114, v9
v_and_b32 v30, v114, v10
v_and_b32 v31, v114, v11
v_and_b32 v32, v115, v8
v_and_b32 v33, v115, v9
v_and_b32 v34, v115, v10
v_and_b32 v35, v115, v11
s_waitcnt vmcnt(5)
v_mfma_f32_16x16x32_bf16 v[12:15], v[28:31], v[76:79], v[12:15]
v_mfma_f32_16x16x32_bf16 v[16:19], v[32:35], v[76:79], v[16:19]
v_and_b32 v20, v116, v8
v_and_b32 v21, v116, v9
v_and_b32 v22, v116, v10
v_and_b32 v23, v116, v11
v_and_b32 v24, v117, v8
v_and_b32 v25, v117, v9
v_and_b32 v26, v117, v10
v_and_b32 v27, v117, v11
s_waitcnt vmcnt(4)
v_mfma_f32_16x16x32_bf16 v[12:15], v[20:23], v[80:83], v[12:15]
v_mfma_f32_16x16x32_bf16 v[16:19], v[24:27], v[80:83], v[16:19]
v_and_b32 v28, v118, v8
v_and_b32 v29, v118, v9
v_and_b32 v30, v118, v10
v_and_b32 v31, v118, v11
v_and_b32 v32, v119, v8
v_and_b32 v33, v119, v9
v_and_b32 v34, v119, v10
v_and_b32 v35, v119, v11
s_waitcnt vmcnt(3)
v_mfma_f32_16x16x32_bf16 v[12:15], v[28:31], v[84:87], v[12:15]
v_mfma_f32_16x16x32_bf16 v[16:19], v[32:35], v[84:87], v[16:19]
v_and_b32 v20, v120, v8
v_and_b32 v21, v120, v9
v_and_b32 v22, v120, v10
v_and_b32 v23, v120, v11
v_and_b32 v24, v121, v8
v_and_b32 v25, v121, v9
v_and_b32 v26, v121, v10
v_and_b32 v27, v121, v11
s_waitcnt vmcnt(2)
v_mfma_f32_16x16x32_bf16 v[12:15], v[20:23], v[88:91], v[12:15]
v_mfma_f32_16x16x32_bf16 v[16:19], v[24:27], v[88:91], v[16:19]
v_and_b32 v28, v122, v8
v_and_b32 v29, v122, v9
v_and_b32 v30, v122, v10
v_and_b32 v31, v122, v11
v_and_b32 v32, v123, v8
v_and_b32 v33, v123, v9
v_and_b32 v34, v123, v10
v_and_b32 v35, v123, v11
s_waitcnt vmcnt(1)
v_mfma_f32_16x16x32_bf16 v[12:15], v[28:31], v[92:95], v[12:15]
v_mfma_f32_16x16x32_bf16 v[16:19], v[32:35], v[92:95], v[16:19]
v_mov_b32 v33, 0xfffff000
v_bfe_u32 v5, v0, 3, 1
v_lshrrev_b32 v7, 5, v0
v_cmp_eq_u32 vcc, v5, v7
s_nop 2
v_mov_b32_dpp v20, v12 row_ror:8 row_mask:0xf bank_mask:0xf
v_mov_b32_dpp v24, v16 row_ror:8 row_mask:0xf bank_mask:0xf
v_mov_b32_dpp v21, v13 row_ror:8 row_mask:0xf bank_mask:0xf
v_mov_b32_dpp v25, v17 row_ror:8 row_mask:0xf bank_mask:0xf
v_mov_b32_dpp v22, v14 row_ror:8 row_mask:0xf bank_mask:0xf
v_mov_b32_dpp v26, v18 row_ror:8 row_mask:0xf bank_mask:0xf
v_mov_b32_dpp v23, v15 row_ror:8 row_mask:0xf bank_mask:0xf
v_mov_b32_dpp v27, v19 row_ror:8 row_mask:0xf bank_mask:0xf
v_permlane32_swap_b32 v20, v24
v_permlane32_swap_b32 v21, v25
v_permlane32_swap_b32 v22, v26
v_permlane32_swap_b32 v23, v27
v_cndmask_b32 v28, v16, v12, s[72:73]
v_cndmask_b32 v20, v20, v24, s[72:73]
v_cndmask_b32 v29, v17, v13, s[72:73]
v_cndmask_b32 v21, v21, v25, s[72:73]
v_cndmask_b32 v30, v18, v14, s[72:73]
v_cndmask_b32 v22, v22, v26, s[72:73]
v_cndmask_b32 v31, v19, v15, s[72:73]
v_cndmask_b32 v23, v23, v27, s[72:73]
v_add_f32 v28, v28, v20
v_add_f32 v29, v29, v21
v_add_f32 v30, v30, v22
v_add_f32 v31, v31, v23
v_and_or_b32 v28, v28, v33, s64
v_and_or_b32 v29, v29, v33, s65
v_and_or_b32 v30, v30, v33, s66
v_and_or_b32 v31, v31, v33, s67
s_mov_b32 s47, 1
s_cmp_eq_u32 s3, 0
s_cbranch_scc0 L_cend
s_mov_b64 s[74:75], vcc
s_getreg_b32 s46, hwreg(HW_REG_XCC_ID)
s_and_b32 s46, s46, 15
s_or_b32 s46, s46, 0x80
s_waitcnt vmcnt(0)
v_cmp_ne_u32 vcc, s46, v36
s_nop 0
s_cmp_eq_u64 vcc, 0
s_cselect_b32 s47, 2, 1
s_mov_b64 vcc, s[74:75]
L_cend:
s_and_saveexec_b64 s[96:97], vcc
s_cmp_eq_u32 s47, 2
s_cbranch_scc0 L_qp1
buffer_store_dwordx4 v[28:31], v4, s[36:39], s98 offen
s_branch L_qp2
L_qp1:
buffer_store_dwordx4 v[28:31], v4, s[36:39], s98 offen sc1
L_qp2:
s_mov_b64 exec, s[96:97]
s_cmp_eq_u32 s3, 0
s_cbranch_scc1 L_qg
s_setprio 0
s_branch L_kv
L_qg:
s_cmp_eq_u32 s2, 0
s_cbranch_scc0 L_nopar
s_getreg_b32 s96, hwreg(HW_REG_XCC_ID)
s_and_b32 s96, s96, 1
s_lshl_b32 s96, s96, 24
s_lshl_b32 s97, s65, 12
s_or_b32 s96, s96, s97
s_or_b32 s96, s96, s64
v_mov_b32 v5, s96
v_mov_b32 v7, 0
s_mov_b64 s[98:99], exec
s_mov_b64 exec, 1
buffer_store_dword v5, v7, s[36:39], 0 offen offset:256 sc1
s_mov_b64 exec, s[98:99]
L_nopar:
s_lshl_b32 s74, s60, 1
s_add_u32 s74, s74, s62
s_lshl_b32 s74, s74, 13
s_add_u32 s74, s74, 4096
s_add_u32 s75, s74, 4096
v_lshlrev_b32 v4, 4, v0
s_mov_b32 s98, 0
v_and_b32 v5, 31, v0
s_lshl_b32 s96, s60, 5
s_cmp_eq_u32 s47, 2
s_cbranch_scc0 L_qds
s_sleep 25
s_branch L_qdd
L_qds:
s_sleep 55
L_qdd:
L_qpoll:
buffer_load_dwordx4 v[100:103], v4, s[36:39], s74 offen offset:0 sc1
buffer_load_dwordx4 v[104:107], v4, s[36:39], s74 offen offset:1024 sc1
buffer_load_dwordx4 v[108:111], v4, s[36:39], s74 offen offset:2048 sc1
buffer_load_dwordx4 v[112:115], v4, s[36:39], s74 offen offset:3072 sc1
buffer_load_dwordx4 v[116:119], v4, s[36:39], s75 offen offset:0 sc1
buffer_load_dwordx4 v[120:123], v4, s[36:39], s75 offen offset:1024 sc1
buffer_load_dwordx4 v[124:127], v4, s[36:39], s75 offen offset:2048 sc1
buffer_load_dwordx4 v[20:23], v4, s[36:39], s75 offen offset:3072 sc1
buffer_load_ubyte v28, v5, s[48:51], s96 offen sc1
s_add_u32 s98, s98, 1
s_waitcnt vmcnt(0)
v_xor_b32 v100, s64, v100
v_xor_b32 v101, s65, v101
v_xor_b32 v102, s66, v102
v_xor_b32 v103, s67, v103
v_xor_b32 v104, s64, v104
v_xor_b32 v105, s65, v105
v_xor_b32 v106, s66, v106
v_xor_b32 v107, s67, v107
v_xor_b32 v108, s64, v108
v_xor_b32 v109, s65, v109
v_xor_b32 v110, s66, v110
v_xor_b32 v111, s67, v111
v_xor_b32 v112, s64, v112
v_xor_b32 v113, s65, v113
v_xor_b32 v114, s66, v114
v_xor_b32 v115, s67, v115
v_xor_b32 v116, s64, v116
v_xor_b32 v117, s65, v117
v_xor_b32 v118, s66, v118
v_xor_b32 v119, s67, v119
v_xor_b32 v120, s64, v120
v_xor_b32 v121, s65, v121
v_xor_b32 v122, s66, v122
v_xor_b32 v123, s67, v123
v_xor_b32 v124, s64, v124
v_xor_b32 v125, s65, v125
v_xor_b32 v126, s66, v126
v_xor_b32 v127, s67, v127
v_xor_b32 v20, s64, v20
v_xor_b32 v21, s65, v21
v_xor_b32 v22, s66, v22
v_xor_b32 v23, s67, v23
v_or3_b32 v16, v100, v101, v102
v_or3_b32 v16, v16, v103, v104
v_or3_b32 v16, v16, v105, v106
v_or3_b32 v16, v16, v107, v108
v_or3_b32 v16, v16, v109, v110
v_or3_b32 v16, v16, v111, v112
v_or3_b32 v16, v16, v113, v114
v_or3_b32 v16, v16, v115, v116
v_or3_b32 v16, v16, v117, v118
v_or3_b32 v16, v16, v119, v120
v_or3_b32 v16, v16, v121, v122
v_or3_b32 v16, v16, v123, v124
v_or3_b32 v16, v16, v125, v126
v_or3_b32 v16, v16, v127, v20
v_or3_b32 v16, v16, v21, v22
v_or_b32 v16, v16, v23
v_and_b32 v16, 0xfff, v16
v_cmp_ne_u32 vcc, 0, v16
s_cbranch_vccz L_qgot
s_sleep 16
s_cmp_gt_u32 s98, 200000
s_cbranch_scc0 L_qpoll
L_qgot:
v_add_f32 v100, v100, v108
v_add_f32 v116, v116, v124
v_add_f32 v101, v101, v109
v_add_f32 v117, v117, v125
v_add_f32 v102, v102, v110
v_add_f32 v118, v118, v126
v_add_f32 v103, v103, v111
v_add_f32 v119, v119, v127
v_add_f32 v104, v104, v112
v_add_f32 v120, v120, v20
v_add_f32 v105, v105, v113
v_add_f32 v121, v121, v21
v_add_f32 v106, v106, v114
v_add_f32 v122, v122, v22
v_add_f32 v107, v107, v115
v_add_f32 v123, v123, v23
v_add_f32 v100, v100, v116
v_add_f32 v101, v101, v117
v_add_f32 v102, v102, v118
v_add_f32 v103, v103, v119
v_add_f32 v104, v104, v120
v_add_f32 v105, v105, v121
v_add_f32 v106, v106, v122
v_add_f32 v107, v107, v123
v_cvt_pk_bf16_f32 v24, v100, v101
v_cvt_pk_bf16_f32 v25, v102, v103
v_cvt_pk_bf16_f32 v26, v104, v105
v_cvt_pk_bf16_f32 v27, v106, v107
v_lshlrev_b32 v4, 3, v0
ds_write_b64 v4, v[24:25] offset:128
ds_write_b64 v4, v[26:27] offset:640
v_cmp_ne_u32 vcc, s46, v28
s_nop 0
s_cmp_eq_u64 vcc, 0
s_cselect_b32 s96, 2, 1
s_waitcnt lgkmcnt(0)
v_mov_b32 v4, 0
v_mov_b32 v5, s96
ds_write_b32 v4, v5 offset:0
s_setprio 0
s_branch L_kv
L_notile:
s_waitcnt lgkmcnt(0)
s_load_dwordx2 s[68:69], s[26:27], 0
s_barrier
s_mov_b32 s48, s24
s_mov_b32 s49, s25
s_mov_b32 s50, 0x100
s_mov_b32 s51, 0x20000
s_getreg_b32 s46, hwreg(HW_REG_XCC_ID)
s_and_b32 s46, s46, 15
s_or_b32 s46, s46, 0x80
s_lshl_b32 s47, s60, 5
v_mov_b32 v5, s46
v_mov_b32 v7, s61
s_mov_b64 exec, 1
buffer_store_byte v5, v7, s[48:51], s47 offen
s_mov_b64 exec, -1
s_mov_b32 s36, s26
s_mov_b32 s37, s27
s_mov_b32 s38, 0x40000000
s_mov_b32 s39, 0x20000
s_mov_b32 s52, s4
s_mov_b32 s53, s5
s_mov_b32 s54, 0x700
s_mov_b32 s55, 0x20000
s_mov_b32 s28, s6
s_mov_b32 s29, s7
s_mov_b32 s30, 0x10000000
s_mov_b32 s31, 0x20000
s_mov_b32 s32, s8
s_mov_b32 s33, s9
s_mov_b32 s34, 0x10000000
s_mov_b32 s35, 0x20000
s_mov_b32 s56, s22
s_mov_b32 s57, s23
s_mov_b32 s58, 0x700
s_mov_b32 s59, 0x20000
v_and_b32 v4, 8, v0
v_cmp_ne_u32 s[70:71], 0, v4
v_cmp_gt_u32 s[72:73], 32, v0
v_and_b32 v4, 7, v0
v_and_b32 v5, 1, v0
v_cmp_eq_u32 vcc, 1, v5
v_mov_b32 v6, 0xffff
v_mov_b32 v7, 0xffff0000
v_cndmask_b32 v6, v6, v7, vcc
v_lshrrev_b32 v4, 1, v4
v_cmp_eq_u32 vcc, 0, v4
s_nop 1
v_cndmask_b32 v8, 0, v6, vcc
v_cmp_eq_u32 vcc, 1, v4
s_nop 1
v_cndmask_b32 v9, 0, v6, vcc
v_cmp_eq_u32 vcc, 2, v4
s_nop 1
v_cndmask_b32 v10, 0, v6, vcc
v_cmp_eq_u32 vcc, 3, v4
s_nop 1
v_cndmask_b32 v11, 0, v6, vcc
v_lshrrev_b32 v4, 4, v0
v_lshlrev_b32 v4, 9, v4
v_and_b32 v5, 15, v0
v_lshlrev_b32 v5, 4, v5
v_add_u32 v1, v4, v5
s_mov_b32 s74, s3
s_add_u32 s74, s74, s63
s_and_b32 s74, s74, 15
s_lshl_b32 s75, s62, 3
s_add_u32 s75, s75, s60
s_lshl_b32 s75, s75, 24
s_add_u32 s75, s75, 0xE00000
s_lshl_b32 s46, s63, 17
s_add_u32 s75, s75, s46
s_lshl_b32 s74, s74, 13
s_add_u32 s44, s74, s75
s_add_u32 s45, s44, 4096
s_waitcnt lgkmcnt(0)
s_add_u32 s68, s68, 1
s_addc_u32 s69, s69, 0
s_mul_i32 s96, s68, 0x7f4a7c15
s_mul_hi_u32 s97, s68, 0x7f4a7c15
s_mul_i32 s75, s68, 0x9e3779b9
s_add_u32 s97, s97, s75
s_mul_i32 s75, s69, 0x7f4a7c15
s_add_u32 s97, s97, s75
s_and_b32 s64, s96, 0xfff
s_bfe_u32 s65, s96, 0xc000c
s_lshr_b32 s66, s96, 24
s_lshl_b32 s75, s97, 8
s_or_b32 s66, s66, s75
s_and_b32 s66, s66, 0xfff
s_bfe_u32 s67, s97, 0xc0004
s_setprio 0
s_branch L_kv
L_dpro:
s_and_b32 s60, s2, 7
s_lshr_b32 s61, s2, 3
s_lshr_b32 s62, s61, 4
s_and_b32 s63, s61, 15
v_and_b32 v4, 8, v0
v_cmp_ne_u32 s[70:71], 0, v4
v_cmp_gt_u32 s[72:73], 32, v0
v_and_b32 v4, 7, v0
v_and_b32 v5, 1, v0
v_cmp_eq_u32 vcc, 1, v5
v_mov_b32 v6, 0xffff
v_mov_b32 v7, 0xffff0000
v_cndmask_b32 v6, v6, v7, vcc
v_lshrrev_b32 v4, 1, v4
v_cmp_eq_u32 vcc, 0, v4
s_nop 1
v_cndmask_b32 v8, 0, v6, vcc
v_cmp_eq_u32 vcc, 1, v4
s_nop 1
v_cndmask_b32 v9, 0, v6, vcc
v_cmp_eq_u32 vcc, 2, v4
s_nop 1
v_cndmask_b32 v10, 0, v6, vcc
v_cmp_eq_u32 vcc, 3, v4
s_nop 1
v_cndmask_b32 v11, 0, v6, vcc
v_lshrrev_b32 v4, 4, v0
v_lshlrev_b32 v4, 9, v4
v_and_b32 v5, 15, v0
v_lshlrev_b32 v5, 4, v5
v_add_u32 v1, v4, v5
s_mov_b32 s74, s3
s_add_u32 s74, s74, s63
s_and_b32 s74, s74, 15
s_lshl_b32 s75, s62, 3
s_add_u32 s75, s75, s60
s_lshl_b32 s75, s75, 24
s_add_u32 s75, s75, 0xE00000
s_lshl_b32 s46, s63, 17
s_add_u32 s75, s75, s46
s_lshl_b32 s74, s74, 13
s_add_u32 s44, s74, s75
s_add_u32 s45, s44, 4096
s_mov_b32 s30, 0x10000000
s_mov_b32 s31, 0x20000
s_mov_b32 s34, 0x10000000
s_mov_b32 s35, 0x20000
s_mov_b32 s38, 0x40000000
s_mov_b32 s39, 0x20000
s_mov_b32 s54, 0x700
s_mov_b32 s55, 0x20000
s_mov_b32 s58, 0x700
s_mov_b32 s59, 0x20000
s_waitcnt lgkmcnt(0)
s_mov_b32 s28, s6
s_mov_b32 s29, s7
s_mov_b32 s32, s8
s_mov_b32 s33, s9
s_mov_b32 s36, s26
s_mov_b32 s37, s27
s_mov_b32 s52, s4
s_mov_b32 s53, s5
s_mov_b32 s56, s22
s_mov_b32 s57, s23
s_load_dwordx2 s[68:69], s[26:27], 0
s_barrier
s_cmp_eq_u32 s3, 15
s_cbranch_scc0 L_nopf
s_getpc_b64 s[96:97]
L_pc:
s_sub_u32 s96, s96, L_pc-recurrent_scan__sliding_block_cached__geglu_ffn__decode_kernel
s_subb_u32 s97, s97, 0
s_lshr_b32 s74, s2, 3
s_mul_i32 s74, s74, 384
v_lshlrev_b32 v4, 6, v0
v_add_u32 v4, s74, v4
v_cmp_gt_u32 s[74:75], 6, v0
v_cmp_gt_u32 vcc, L_codeend-recurrent_scan__sliding_block_cached__geglu_ffn__decode_kernel, v4
s_nop 0
s_and_b64 vcc, vcc, s[74:75]
s_and_saveexec_b64 s[74:75], vcc
s_cbranch_execz L_pfskip
global_load_dword v36, v4, s[96:97]
L_pfskip:
s_mov_b64 exec, s[74:75]
L_nopf:
L_kv:
s_cmp_lt_u32 s3, 12
s_cbranch_scc1 L_nowo0
s_lshl_b32 s46, s60, 9
s_lshl_b32 s97, s61, 4
s_add_u32 s46, s46, s97
s_mul_i32 s46, s46, 896
s_sub_u32 s97, s3, 12
s_lshl_b32 s97, s97, 8
s_add_u32 s46, s46, s97
v_lshrrev_b32 v4, 4, v0
v_mul_u32_u24 v4, 3584, v4
v_and_b32 v5, 15, v0
v_lshlrev_b32 v5, 4, v5
v_add_u32 v2, v4, v5
L_nowo0:
s_and_b32 s97, s3, 0xb
s_cmp_eq_u32 s97, 2
s_cbranch_scc1 L_tok
s_cmp_eq_u32 s97, 3
s_cbranch_scc1 L_tok
s_lshl_b32 s97, s3, 2
v_mov_b32 v6, s97
s_mov_b32 s98, 0
L_tokw:
ds_read_b32 v7, v6 offset:64
s_add_u32 s98, s98, 1
s_waitcnt lgkmcnt(0)
v_cmp_ne_u32 vcc, 0, v7
s_cbranch_vccnz L_tok
s_cmp_gt_u32 s98, 1600000
s_cbranch_scc1 L_tok
s_sleep 1
s_branch L_tokw
L_tok:
s_cmp_lt_u32 s3, 12
s_cbranch_scc0 L_last
buffer_load_dwordx4 v[36:39], v1, s[28:31], s44 offen offset:0 nt
buffer_load_dwordx4 v[40:43], v1, s[28:31], s44 offen offset:256 nt
buffer_load_dwordx4 v[44:47], v1, s[28:31], s44 offen offset:2048 nt
buffer_load_dwordx4 v[48:51], v1, s[28:31], s44 offen offset:2304 nt
buffer_load_dwordx4 v[52:55], v1, s[28:31], s45 offen offset:0 nt
buffer_load_dwordx4 v[56:59], v1, s[28:31], s45 offen offset:256 nt
buffer_load_dwordx4 v[60:63], v1, s[28:31], s45 offen offset:2048 nt
buffer_load_dwordx4 v[64:67], v1, s[28:31], s45 offen offset:2304 nt
s_waitcnt vmcnt(7)
buffer_load_dwordx4 v[68:71], v1, s[32:35], s44 offen offset:0 nt
s_waitcnt vmcnt(7)
buffer_load_dwordx4 v[72:75], v1, s[32:35], s44 offen offset:256 nt
s_waitcnt vmcnt(7)
buffer_load_dwordx4 v[76:79], v1, s[32:35], s44 offen offset:2048 nt
s_waitcnt vmcnt(7)
buffer_load_dwordx4 v[80:83], v1, s[32:35], s44 offen offset:2304 nt
s_waitcnt vmcnt(7)
buffer_load_dwordx4 v[84:87], v1, s[32:35], s45 offen offset:0 nt
s_waitcnt vmcnt(7)
buffer_load_dwordx4 v[88:91], v1, s[32:35], s45 offen offset:256 nt
s_waitcnt vmcnt(7)
buffer_load_dwordx4 v[92:95], v1, s[32:35], s45 offen offset:2048 nt
s_waitcnt vmcnt(7)
buffer_load_dwordx4 v[96:99], v1, s[32:35], s45 offen offset:2304 nt
s_branch L_rel
L_last:
s_mov_b32 s40, s12
s_mov_b32 s41, s13
s_mov_b32 s42, 0x380000
s_mov_b32 s43, 0x20000
buffer_load_dwordx4 v[36:39], v1, s[28:31], s44 offen offset:0 nt
buffer_load_dwordx4 v[40:43], v1, s[28:31], s44 offen offset:256 nt
buffer_load_dwordx4 v[44:47], v1, s[28:31], s44 offen offset:2048 nt
buffer_load_dwordx4 v[48:51], v1, s[28:31], s44 offen offset:2304 nt
buffer_load_dwordx4 v[52:55], v1, s[28:31], s45 offen offset:0 nt
buffer_load_dwordx4 v[56:59], v1, s[28:31], s45 offen offset:256 nt
buffer_load_dwordx4 v[60:63], v1, s[28:31], s45 offen offset:2048 nt
buffer_load_dwordx4 v[64:67], v1, s[28:31], s45 offen offset:2304 nt
buffer_load_dwordx4 v[68:71], v1, s[32:35], s44 offen offset:0 nt
buffer_load_dwordx4 v[72:75], v1, s[32:35], s44 offen offset:256 nt
buffer_load_dwordx4 v[76:79], v1, s[32:35], s44 offen offset:2048 nt
buffer_load_dwordx4 v[80:83], v1, s[32:35], s44 offen offset:2304 nt
s_waitcnt vmcnt(11)
buffer_load_dwordx4 v[84:87], v1, s[32:35], s45 offen offset:0 nt
s_waitcnt vmcnt(11)
buffer_load_dwordx4 v[88:91], v1, s[32:35], s45 offen offset:256 nt
s_waitcnt vmcnt(11)
buffer_load_dwordx4 v[92:95], v1, s[32:35], s45 offen offset:2048 nt
s_waitcnt vmcnt(11)
buffer_load_dwordx4 v[96:99], v1, s[32:35], s45 offen offset:2304 nt
buffer_load_dwordx4 v[100:103], v2, s[40:43], s46 offen offset:0 nt
buffer_load_dwordx4 v[104:107], v2, s[40:43], s46 offen offset:896 nt
buffer_load_dwordx4 v[108:111], v2, s[40:43], s46 offen offset:1792 nt
buffer_load_dwordx4 v[112:115], v2, s[40:43], s46 offen offset:2688 nt
s_branch L_nowo
L_rel:
s_waitcnt vmcnt(7)
v_mov_b32 v6, 0
v_mov_b32 v7, 1
s_mov_b64 s[96:97], exec
s_mov_b64 exec, 1
ds_add_rtn_u32 v2, v6, v7 offset:16
s_mov_b32 s74, 0x9810ba54
s_mov_b32 s75, 0xfedc
s_waitcnt lgkmcnt(0)
v_readfirstlane_b32 s98, v2
s_nop 0
s_lshl_b32 s98, s98, 2
s_lshr_b64 s[74:75], s[74:75], s98
s_and_b32 s98, s74, 15
s_lshl_b32 s98, s98, 2
v_mov_b32 v6, s98
ds_write_b32 v6, v7 offset:64
s_mov_b64 exec, s[96:97]
L_nowo:
s_cmp_lt_u32 s3, 2
s_cbranch_scc1 L_havetags
s_waitcnt lgkmcnt(0)
s_add_u32 s68, s68, 1
s_addc_u32 s69, s69, 0
s_mul_i32 s96, s68, 0x7f4a7c15
s_mul_hi_u32 s97, s68, 0x7f4a7c15
s_mul_i32 s75, s68, 0x9e3779b9
s_add_u32 s97, s97, s75
s_mul_i32 s75, s69, 0x7f4a7c15
s_add_u32 s97, s97, s75
s_and_b32 s64, s96, 0xfff
s_bfe_u32 s65, s96, 0xc000c
s_lshr_b32 s66, s96, 24
s_lshl_b32 s75, s97, 8
s_or_b32 s66, s66, s75
s_and_b32 s66, s66, 0xfff
s_bfe_u32 s67, s97, 0xc0004
L_havetags:
v_mov_b32 v2, 0
s_mov_b32 s97, 0
L_qwait:
ds_read_b32 v3, v2 offset:0
s_add_u32 s97, s97, 1
s_waitcnt lgkmcnt(0)
v_cmp_ne_u32 vcc, 0, v3
s_cbranch_vccnz L_qok
s_cmp_gt_u32 s97, 1600000
s_cbranch_scc1 L_qok
s_sleep 2
s_branch L_qwait
L_qok:
v_readfirstlane_b32 s100, v3
v_and_b32 v4, 15, v0
v_lshlrev_b32 v4, 4, v4
ds_read_b128 v[20:23], v4 offset:128
ds_read_b128 v[24:27], v4 offset:384
ds_read_b128 v[28:31], v4 offset:640
ds_read_b128 v[32:35], v4 offset:896
v_lshrrev_b32 v5, 5, v0
v_lshlrev_b32 v5, 10, v5
v_and_b32 v6, 15, v0
v_lshlrev_b32 v6, 5, v6
v_bfe_u32 v7, v0, 4, 1
v_lshlrev_b32 v7, 4, v7
v_add3_u32 v5, v5, v6, v7
s_mul_i32 s96, s3, 2064
v_add_u32 v5, s96, v5
v_and_b32 v6, 8, v0
s_lshl_b32 s96, s3, 4
v_add_u32 v6, s96, v6
v_and_b32 v7, 0x37, v0
v_cmp_eq_u32 s[46:47], 0, v7
s_cmp_lt_u32 s3, 12
s_cbranch_scc1 L_kw0
s_waitcnt vmcnt(12) lgkmcnt(0)
s_branch L_kw1
L_kw0:
s_waitcnt vmcnt(8) lgkmcnt(0)
L_kw1:
v_dot2_f32_bf16 v116, v36, v20, 0
v_dot2_f32_bf16 v117, v36, v28, 0
s_nop 1
v_dot2c_f32_bf16 v116, v37, v21
v_dot2c_f32_bf16 v117, v37, v29
v_dot2c_f32_bf16 v116, v38, v22
v_dot2c_f32_bf16 v117, v38, v30
v_dot2c_f32_bf16 v116, v39, v23
v_dot2c_f32_bf16 v117, v39, v31
v_dot2c_f32_bf16 v116, v40, v24
v_dot2c_f32_bf16 v117, v40, v32
v_dot2c_f32_bf16 v116, v41, v25
v_dot2c_f32_bf16 v117, v41, v33
v_dot2c_f32_bf16 v116, v42, v26
v_dot2c_f32_bf16 v117, v42, v34
v_dot2c_f32_bf16 v116, v43, v27
v_dot2c_f32_bf16 v117, v43, v35
v_dot2_f32_bf16 v118, v44, v20, 0
v_dot2_f32_bf16 v119, v44, v28, 0
s_nop 1
v_dot2c_f32_bf16 v118, v45, v21
v_dot2c_f32_bf16 v119, v45, v29
v_dot2c_f32_bf16 v118, v46, v22
v_dot2c_f32_bf16 v119, v46, v30
v_dot2c_f32_bf16 v118, v47, v23
v_dot2c_f32_bf16 v119, v47, v31
v_dot2c_f32_bf16 v118, v48, v24
v_dot2c_f32_bf16 v119, v48, v32
v_dot2c_f32_bf16 v118, v49, v25
v_dot2c_f32_bf16 v119, v49, v33
v_dot2c_f32_bf16 v118, v50, v26
v_dot2c_f32_bf16 v119, v50, v34
v_dot2c_f32_bf16 v118, v51, v27
v_dot2c_f32_bf16 v119, v51, v35
v_dot2_f32_bf16 v120, v52, v20, 0
v_dot2_f32_bf16 v121, v52, v28, 0
s_nop 1
v_dot2c_f32_bf16 v120, v53, v21
v_dot2c_f32_bf16 v121, v53, v29
v_dot2c_f32_bf16 v120, v54, v22
v_dot2c_f32_bf16 v121, v54, v30
v_dot2c_f32_bf16 v120, v55, v23
v_dot2c_f32_bf16 v121, v55, v31
v_dot2c_f32_bf16 v120, v56, v24
v_dot2c_f32_bf16 v121, v56, v32
v_dot2c_f32_bf16 v120, v57, v25
v_dot2c_f32_bf16 v121, v57, v33
v_dot2c_f32_bf16 v120, v58, v26
v_dot2c_f32_bf16 v121, v58, v34
v_dot2c_f32_bf16 v120, v59, v27
v_dot2c_f32_bf16 v121, v59, v35
v_dot2_f32_bf16 v122, v60, v20, 0
v_dot2_f32_bf16 v123, v60, v28, 0
s_nop 1
v_dot2c_f32_bf16 v122, v61, v21
v_dot2c_f32_bf16 v123, v61, v29
v_dot2c_f32_bf16 v122, v62, v22
v_dot2c_f32_bf16 v123, v62, v30
v_dot2c_f32_bf16 v122, v63, v23
v_dot2c_f32_bf16 v123, v63, v31
v_dot2c_f32_bf16 v122, v64, v24
v_dot2c_f32_bf16 v123, v64, v32
v_dot2c_f32_bf16 v122, v65, v25
v_dot2c_f32_bf16 v123, v65, v33
v_dot2c_f32_bf16 v122, v66, v26
v_dot2c_f32_bf16 v123, v66, v34
v_dot2c_f32_bf16 v122, v67, v27
v_dot2c_f32_bf16 v123, v67, v35
v_cndmask_b32 v124, v116, v117, s[70:71]
v_cndmask_b32 v125, v118, v119, s[70:71]
v_cndmask_b32 v126, v120, v121, s[70:71]
v_cndmask_b32 v127, v122, v123, s[70:71]
v_cndmask_b32 v36, v117, v116, s[70:71]
v_cndmask_b32 v37, v119, v118, s[70:71]
v_cndmask_b32 v38, v121, v120, s[70:71]
v_cndmask_b32 v39, v123, v122, s[70:71]
v_add_f32_dpp v124, v36, v124 row_ror:8 row_mask:0xf bank_mask:0xf
v_add_f32_dpp v125, v37, v125 row_ror:8 row_mask:0xf bank_mask:0xf
v_add_f32_dpp v126, v38, v126 row_ror:8 row_mask:0xf bank_mask:0xf
v_add_f32_dpp v127, v39, v127 row_ror:8 row_mask:0xf bank_mask:0xf
v_add_f32_dpp v124, v124, v124 quad_perm:[1,0,3,2] row_mask:0xf bank_mask:0xf
v_add_f32_dpp v125, v125, v125 quad_perm:[1,0,3,2] row_mask:0xf bank_mask:0xf
v_add_f32_dpp v126, v126, v126 quad_perm:[1,0,3,2] row_mask:0xf bank_mask:0xf
v_add_f32_dpp v127, v127, v127 quad_perm:[1,0,3,2] row_mask:0xf bank_mask:0xf
v_add_f32_dpp v124, v124, v124 quad_perm:[2,3,0,1] row_mask:0xf bank_mask:0xf
v_add_f32_dpp v125, v125, v125 quad_perm:[2,3,0,1] row_mask:0xf bank_mask:0xf
v_add_f32_dpp v126, v126, v126 quad_perm:[2,3,0,1] row_mask:0xf bank_mask:0xf
v_add_f32_dpp v127, v127, v127 quad_perm:[2,3,0,1] row_mask:0xf bank_mask:0xf
v_add_f32_dpp v124, v124, v124 row_half_mirror row_mask:0xf bank_mask:0xf
v_add_f32_dpp v125, v125, v125 row_half_mirror row_mask:0xf bank_mask:0xf
v_add_f32_dpp v126, v126, v126 row_half_mirror row_mask:0xf bank_mask:0xf
v_add_f32_dpp v127, v127, v127 row_half_mirror row_mask:0xf bank_mask:0xf
v_cvt_pk_bf16_f32 v124, v124, v124
v_cvt_pk_bf16_f32 v125, v125, v125
v_cvt_pk_bf16_f32 v126, v126, v126
v_cvt_pk_bf16_f32 v127, v127, v127
v_and_b32 v124, 0xffff0000, v124
v_and_b32 v125, 0xffff0000, v125
v_and_b32 v126, 0xffff0000, v126
v_and_b32 v127, 0xffff0000, v127
v_max3_f32 v116, v124, v125, v126
v_max_f32 v116, v116, v127
v_mov_b32 v117, v116
s_nop 1
v_permlane16_swap_b32 v116, v117
v_max_f32 v116, v116, v117
v_mov_b32 v117, v116
s_nop 1
v_permlane32_swap_b32 v116, v117
v_max_f32 v116, v116, v117
s_mov_b32 s96, 0x3db8aa3b
v_sub_f32 v124, v124, v116
v_sub_f32 v125, v125, v116
v_sub_f32 v126, v126, v116
v_sub_f32 v127, v127, v116
v_mul_f32 v124, s96, v124
v_mul_f32 v125, s96, v125
v_mul_f32 v126, s96, v126
v_mul_f32 v127, s96, v127
v_exp_f32 v124, v124
v_exp_f32 v125, v125
v_exp_f32 v126, v126
v_exp_f32 v127, v127
v_cvt_pk_bf16_f32 v36, v124, v124
v_cvt_pk_bf16_f32 v37, v125, v125
v_cvt_pk_bf16_f32 v38, v126, v126
v_cvt_pk_bf16_f32 v39, v127, v127
v_add_f32 v117, v124, v125
v_add_f32 v118, v126, v127
v_and_b32 v40, v36, v8
v_and_b32 v41, v36, v9
v_and_b32 v42, v36, v10
v_and_b32 v43, v36, v11
v_add_f32 v117, v117, v118
v_and_b32 v44, v37, v8
v_and_b32 v45, v37, v9
v_and_b32 v46, v37, v10
v_and_b32 v47, v37, v11
v_mov_b32 v118, v117
v_and_b32 v48, v38, v8
v_and_b32 v49, v38, v9
v_and_b32 v50, v38, v10
v_and_b32 v51, v38, v11
v_permlane16_swap_b32 v117, v118
v_add_f32 v117, v117, v118
v_and_b32 v52, v39, v8
v_and_b32 v53, v39, v9
v_and_b32 v54, v39, v10
v_and_b32 v55, v39, v11
v_mov_b32 v118, v117
s_nop 1
v_permlane32_swap_b32 v117, v118
v_add_f32 v117, v117, v118
s_mov_b64 s[74:75], exec
s_mov_b64 exec, s[46:47]
ds_write_b64 v6, v[116:117] offset:3136
s_mov_b64 exec, s[74:75]
s_waitcnt vmcnt(10)
s_cmp_lt_u32 s3, 12
s_cbranch_scc0 L_vw0
s_waitcnt vmcnt(6)
L_vw0:
v_mfma_f32_16x16x32_bf16 v[12:15], v[40:43], v[68:71], 0
v_mfma_f32_16x16x32_bf16 v[16:19], v[40:43], v[72:75], 0
s_waitcnt vmcnt(8)
s_cmp_lt_u32 s3, 12
s_cbranch_scc0 L_vw1
s_waitcnt vmcnt(4)
L_vw1:
v_mfma_f32_16x16x32_bf16 v[12:15], v[44:47], v[76:79], v[12:15]
v_mfma_f32_16x16x32_bf16 v[16:19], v[44:47], v[80:83], v[16:19]
s_waitcnt vmcnt(6)
s_cmp_lt_u32 s3, 12
s_cbranch_scc0 L_vw2
s_waitcnt vmcnt(2)
L_vw2:
v_mfma_f32_16x16x32_bf16 v[12:15], v[48:51], v[84:87], v[12:15]
v_mfma_f32_16x16x32_bf16 v[16:19], v[48:51], v[88:91], v[16:19]
s_waitcnt vmcnt(4)
s_cmp_lt_u32 s3, 12
s_cbranch_scc0 L_vw3
s_waitcnt vmcnt(0)
L_vw3:
v_mfma_f32_16x16x32_bf16 v[12:15], v[52:55], v[92:95], v[12:15]
v_mfma_f32_16x16x32_bf16 v[16:19], v[52:55], v[96:99], v[16:19]
s_nop 6
ds_write_b128 v5, v[12:15] offset:6976
ds_write_b128 v5, v[16:19] offset:7488
s_mov_b32 s99, 0
s_cmp_eq_u32 s3, 3
s_cbranch_scc0 L_ffn2_done
s_cmp_lt_u32 s2, 224
s_cbranch_scc0 L_ffn2_done
s_lshl_b32 s75, s65, 12
s_or_b32 s75, s75, s64
v_mov_b32 v7, 0
s_mov_b32 s98, 0
L_parw:
buffer_load_dword v4, v7, s[36:39], 0 offen offset:256 sc1
s_add_u32 s98, s98, 1
s_waitcnt vmcnt(0)
v_readfirstlane_b32 s74, v4
s_nop 0
s_and_b32 s96, s74, 0xffffff
s_cmp_eq_u32 s96, s75
s_cbranch_scc1 L_parok
s_sleep 16
s_cmp_gt_u32 s98, 200000
s_cbranch_scc0 L_parw
L_parok:
s_lshr_b32 s74, s74, 24
s_xor_b32 s74, s74, s2
s_and_b32 s74, s74, 1
s_xor_b32 s99, s74, 1
s_cmp_eq_u32 s99, 1
s_cbranch_scc1 L_ffn2
L_ffn2_done:
s_sub_u32 s74, s3, 4
s_cmp_lt_u32 s74, 4
s_cbranch_scc0 L_bar2
v_and_b32 v4, 31, v0
v_lshlrev_b32 v5, 4, v4
v_lshrrev_b32 v6, 5, v0
v_mul_u32_u24 v7, 16512, v6
v_add_u32 v5, v5, v7
s_lshr_b32 s75, s74, 1
s_lshl_b32 s96, s75, 10
s_and_b32 s97, s74, 1
s_lshl_b32 s97, s97, 9
s_add_u32 s96, s96, s97
v_add_u32 v5, s96, v5
v_lshlrev_b32 v7, 3, v6
v_add_u32 v7, v7, v0
v_and_b32 v7, 15, v7
v_lshlrev_b32 v7, 4, v7
s_lshl_b32 s96, s75, 3
v_lshlrev_b32 v3, 6, v6
v_add_u32 v6, s96, v7
v_lshrrev_b32 v7, 2, v4
v_mul_u32_u24 v7, 4224, v7
v_and_b32 v4, 3, v0
v_lshlrev_b32 v4, 4, v4
v_add3_u32 v7, v7, v4, v3
s_lshl_b32 s75, s60, 5
s_lshl_b32 s96, s74, 3
s_add_u32 s75, s75, s96
s_mul_i32 s75, s75, 4224
s_lshr_b32 s96, s63, 2
s_lshl_b32 s96, s96, 3
s_lshl_b32 s97, s62, 2
s_add_u32 s96, s96, s97
s_and_b32 s97, s63, 3
s_add_u32 s96, s96, s97
s_lshl_b32 s96, s96, 7
s_add_u32 s75, s75, s96
s_add_u32 s75, s75, 262144
v_mov_b32 v33, 0xfffff000
s_mov_b32 s96, 0x3db8aa3b
s_setprio 3
L_bar2:
s_waitcnt lgkmcnt(0)
s_barrier
s_cmp_lt_u32 s74, 4
s_cbranch_scc0 L_notcomb
ds_read_b64 v[28:29], v6 offset:3136
ds_read_b128 v[36:39], v5 offset:6976
ds_read_b128 v[40:43], v5 offset:9040
ds_read_b128 v[44:47], v5 offset:11104
ds_read_b128 v[48:51], v5 offset:13168
ds_read_b128 v[52:55], v5 offset:15232
ds_read_b128 v[56:59], v5 offset:17296
ds_read_b128 v[60:63], v5 offset:19360
ds_read_b128 v[64:67], v5 offset:21424
s_waitcnt lgkmcnt(8)
v_mov_b32 v34, v28
s_nop 1
v_max_f32_dpp v34, v34, v34 row_ror:8 row_mask:0xf bank_mask:0xf
s_nop 1
v_max_f32_dpp v34, v34, v34 row_ror:4 row_mask:0xf bank_mask:0xf
s_nop 1
v_max_f32_dpp v34, v34, v34 row_ror:2 row_mask:0xf bank_mask:0xf
s_nop 1
v_max_f32_dpp v34, v34, v34 row_ror:1 row_mask:0xf bank_mask:0xf
v_sub_f32 v35, v28, v34
v_mul_f32 v35, s96, v35
v_exp_f32 v35, v35
s_nop 0
v_mul_f32 v29, v35, v29
s_waitcnt lgkmcnt(7)
v_mul_f32_dpp v20, v35, v36 row_newbcast:0 row_mask:0xf bank_mask:0xf
v_mul_f32_dpp v21, v35, v37 row_newbcast:0 row_mask:0xf bank_mask:0xf
v_mul_f32_dpp v22, v35, v38 row_newbcast:0 row_mask:0xf bank_mask:0xf
v_mul_f32_dpp v23, v35, v39 row_newbcast:0 row_mask:0xf bank_mask:0xf
v_add_f32_dpp v29, v29, v29 row_ror:8 row_mask:0xf bank_mask:0xf
s_waitcnt lgkmcnt(6)
v_fmac_f32_dpp v20, v35, v40 row_newbcast:1 row_mask:0xf bank_mask:0xf
v_fmac_f32_dpp v21, v35, v41 row_newbcast:1 row_mask:0xf bank_mask:0xf
v_fmac_f32_dpp v22, v35, v42 row_newbcast:1 row_mask:0xf bank_mask:0xf
v_fmac_f32_dpp v23, v35, v43 row_newbcast:1 row_mask:0xf bank_mask:0xf
v_add_f32_dpp v29, v29, v29 row_ror:4 row_mask:0xf bank_mask:0xf
s_waitcnt lgkmcnt(5)
v_fmac_f32_dpp v20, v35, v44 row_newbcast:2 row_mask:0xf bank_mask:0xf
v_fmac_f32_dpp v21, v35, v45 row_newbcast:2 row_mask:0xf bank_mask:0xf
v_fmac_f32_dpp v22, v35, v46 row_newbcast:2 row_mask:0xf bank_mask:0xf
v_fmac_f32_dpp v23, v35, v47 row_newbcast:2 row_mask:0xf bank_mask:0xf
v_add_f32_dpp v29, v29, v29 row_ror:2 row_mask:0xf bank_mask:0xf
s_waitcnt lgkmcnt(4)
v_fmac_f32_dpp v20, v35, v48 row_newbcast:3 row_mask:0xf bank_mask:0xf
v_fmac_f32_dpp v21, v35, v49 row_newbcast:3 row_mask:0xf bank_mask:0xf
v_fmac_f32_dpp v22, v35, v50 row_newbcast:3 row_mask:0xf bank_mask:0xf
v_fmac_f32_dpp v23, v35, v51 row_newbcast:3 row_mask:0xf bank_mask:0xf
v_add_f32_dpp v29, v29, v29 row_ror:1 row_mask:0xf bank_mask:0xf
s_waitcnt lgkmcnt(3)
v_fmac_f32_dpp v20, v35, v52 row_newbcast:4 row_mask:0xf bank_mask:0xf
v_fmac_f32_dpp v21, v35, v53 row_newbcast:4 row_mask:0xf bank_mask:0xf
v_fmac_f32_dpp v22, v35, v54 row_newbcast:4 row_mask:0xf bank_mask:0xf
v_fmac_f32_dpp v23, v35, v55 row_newbcast:4 row_mask:0xf bank_mask:0xf
s_waitcnt lgkmcnt(2)
v_fmac_f32_dpp v20, v35, v56 row_newbcast:5 row_mask:0xf bank_mask:0xf
v_fmac_f32_dpp v21, v35, v57 row_newbcast:5 row_mask:0xf bank_mask:0xf
v_fmac_f32_dpp v22, v35, v58 row_newbcast:5 row_mask:0xf bank_mask:0xf
v_fmac_f32_dpp v23, v35, v59 row_newbcast:5 row_mask:0xf bank_mask:0xf
s_waitcnt lgkmcnt(1)
v_fmac_f32_dpp v20, v35, v60 row_newbcast:6 row_mask:0xf bank_mask:0xf
v_fmac_f32_dpp v21, v35, v61 row_newbcast:6 row_mask:0xf bank_mask:0xf
v_fmac_f32_dpp v22, v35, v62 row_newbcast:6 row_mask:0xf bank_mask:0xf
v_fmac_f32_dpp v23, v35, v63 row_newbcast:6 row_mask:0xf bank_mask:0xf
s_waitcnt lgkmcnt(0)
v_fmac_f32_dpp v20, v35, v64 row_newbcast:7 row_mask:0xf bank_mask:0xf
v_fmac_f32_dpp v21, v35, v65 row_newbcast:7 row_mask:0xf bank_mask:0xf
v_fmac_f32_dpp v22, v35, v66 row_newbcast:7 row_mask:0xf bank_mask:0xf
v_fmac_f32_dpp v23, v35, v67 row_newbcast:7 row_mask:0xf bank_mask:0xf
v_mov_b32 v24, v20
v_mov_b32 v25, v21
v_mov_b32 v26, v22
v_mov_b32 v27, v23
v_permlane32_swap_b32 v20, v24
v_permlane32_swap_b32 v21, v25
v_permlane32_swap_b32 v22, v26
v_permlane32_swap_b32 v23, v27
v_add_f32 v20, v20, v24
v_add_f32 v21, v21, v25
v_add_f32 v22, v22, v26
v_add_f32 v23, v23, v27
v_cndmask_b32 v20, v34, v20, s[72:73]
v_cndmask_b32 v21, v29, v21, s[72:73]
v_cndmask_b32 v22, v34, v22, s[72:73]
v_cndmask_b32 v23, v29, v23, s[72:73]
v_and_or_b32 v20, v20, v33, s64
v_and_or_b32 v21, v21, v33, s65
v_and_or_b32 v22, v22, v33, s66
v_and_or_b32 v23, v23, v33, s67
s_cmp_eq_u32 s100, 2
s_cbranch_scc1 L_p1fast
buffer_store_dwordx4 v[20:23], v7, s[36:39], s75 offen sc1
s_branch L_p1pub
L_p1fast:
buffer_store_dwordx4 v[20:23], v7, s[36:39], s75 offen
L_p1pub:
v_mov_b32 v2, 0
v_mov_b32 v3, 1
s_mov_b64 s[96:97], exec
s_mov_b64 exec, 1
ds_add_u32 v2, v3 offset:8
s_mov_b64 exec, s[96:97]
s_setprio 0
s_branch L_aux_done
L_notcomb:
s_cmp_lt_u32 s3, 12
s_cbranch_scc1 L_aux
s_setprio 3
s_lshl_b32 s74, s60, 5
s_add_u32 s74, s74, s61
s_mul_i32 s74, s74, 4224
s_add_u32 s74, s74, 262144
v_lshlrev_b32 v4, 4, v0
s_mov_b32 s98, 0
s_cmp_eq_u32 s100, 2
s_cbranch_scc1 L_p1df
v_mov_b32 v2, 0
s_mov_b32 s97, 0
L_pubw:
ds_read_b32 v3, v2 offset:8
s_add_u32 s97, s97, 1
s_waitcnt lgkmcnt(0)
v_cmp_le_u32 vcc, 4, v3
s_cbranch_vccnz L_pubw_ok
s_cmp_gt_u32 s97, 1600000
s_cbranch_scc0 L_pubw
L_pubw_ok:
s_sleep 32
L_p1df:
buffer_load_dwordx4 v[36:39], v4, s[36:39], s74 offen offset:0 sc1
buffer_load_dwordx4 v[40:43], v4, s[36:39], s74 offen offset:1024 sc1
buffer_load_dwordx4 v[44:47], v4, s[36:39], s74 offen offset:2048 sc1
buffer_load_dwordx4 v[48:51], v4, s[36:39], s74 offen offset:3072 sc1
v_lshrrev_b32 v6, 5, v0
v_mul_u32_u24 v6, 14, v6
v_bfe_u32 v7, v0, 2, 2
v_add_u32 v6, v6, v7
v_mul_u32_u24 v5, 32896, v6
v_and_b32 v6, 3, v0
v_lshlrev_b32 v6, 5, v6
v_bfe_u32 v7, v0, 4, 1
v_lshlrev_b32 v7, 4, v7
v_add3_u32 v5, v5, v6, v7
s_sub_u32 s75, s3, 12
s_mul_i32 s99, s75, 131584
s_lshl_b32 s97, s60, 5
s_add_u32 s97, s97, s61
s_lshl_b32 s97, s97, 7
s_add_u32 s99, s99, s97
s_add_u32 s99, s99, 1376256
v_bfe_u32 v6, v0, 3, 1
v_lshlrev_b32 v6, 7, v6
v_lshrrev_b32 v16, 4, v0
v_lshlrev_b32 v16, 2, v16
v_add_u32 v6, v6, v16
v_add_u32 v7, 64, v6
v_mov_b32 v33, 0xfffff000
s_mov_b32 s96, 0x3db8aa3b
s_cmp_eq_u32 s3, 15
s_cselect_b32 s97, 8, 16
v_and_b32 v20, 15, v0
v_cmp_gt_u32 s[46:47], s97, v20
s_branch L_p1chk
L_p1poll:
s_cmp_eq_u32 s100, 2
s_cbranch_scc1 L_p1rf
s_sleep 16
L_p1rf:
buffer_load_dwordx4 v[36:39], v4, s[36:39], s74 offen offset:0 sc1
buffer_load_dwordx4 v[40:43], v4, s[36:39], s74 offen offset:1024 sc1
buffer_load_dwordx4 v[44:47], v4, s[36:39], s74 offen offset:2048 sc1
buffer_load_dwordx4 v[48:51], v4, s[36:39], s74 offen offset:3072 sc1
L_p1chk:
s_add_u32 s98, s98, 1
s_waitcnt vmcnt(0)
v_xor_b32 v36, s64, v36
v_xor_b32 v37, s65, v37
v_xor_b32 v38, s66, v38
v_xor_b32 v39, s67, v39
v_xor_b32 v40, s64, v40
v_xor_b32 v41, s65, v41
v_xor_b32 v42, s66, v42
v_xor_b32 v43, s67, v43
v_xor_b32 v44, s64, v44
v_xor_b32 v45, s65, v45
v_xor_b32 v46, s66, v46
v_xor_b32 v47, s67, v47
v_xor_b32 v48, s64, v48
v_xor_b32 v49, s65, v49
v_xor_b32 v50, s66, v50
v_xor_b32 v51, s67, v51
v_or3_b32 v16, v36, v37, v38
v_or3_b32 v16, v16, v39, v40
v_or3_b32 v16, v16, v41, v42
v_or3_b32 v16, v16, v43, v44
v_or3_b32 v16, v16, v45, v46
v_or3_b32 v16, v16, v47, v48
v_or3_b32 v16, v16, v49, v50
v_or_b32 v16, v16, v51
v_and_b32 v16, 0xfff, v16
v_cmp_ne_u32 vcc, 0, v16
s_cbranch_vccz L_p1ok
s_cmp_gt_u32 s98, 200000
s_cbranch_scc0 L_p1poll
L_p1ok:
v_max3_f32 v16, v36, v40, v44
v_max_f32 v16, v16, v48
s_nop 1
v_max_f32_dpp v16, v16, v16 row_ror:8 row_mask:0xf bank_mask:0xf
v_mov_b32 v17, v16
s_nop 1
v_permlane16_swap_b32 v16, v17
v_max_f32 v16, v16, v17
v_sub_f32 v20, v36, v16
v_sub_f32 v21, v40, v16
v_sub_f32 v22, v44, v16
v_sub_f32 v23, v48, v16
v_mul_f32 v20, s96, v20
v_mul_f32 v21, s96, v21
v_mul_f32 v22, s96, v22
v_mul_f32 v23, s96, v23
v_exp_f32 v20, v20
v_exp_f32 v21, v21
v_exp_f32 v22, v22
v_exp_f32 v23, v23
v_mul_f32 v17, v20, v37
v_fmac_f32 v17, v21, v41
v_fmac_f32 v17, v22, v45
v_fmac_f32 v17, v23, v49
v_mul_f32_dpp v24, v20, v36 row_shl:4 row_mask:0xf bank_mask:0xf
v_mul_f32_dpp v25, v20, v37 row_shl:4 row_mask:0xf bank_mask:0xf
v_mul_f32_dpp v26, v20, v38 row_shl:4 row_mask:0xf bank_mask:0xf
v_mul_f32_dpp v27, v20, v39 row_shl:4 row_mask:0xf bank_mask:0xf
v_add_f32_dpp v17, v17, v17 row_ror:8 row_mask:0xf bank_mask:0xf
v_fmac_f32_dpp v24, v21, v40 row_shl:4 row_mask:0xf bank_mask:0xf
v_fmac_f32_dpp v25, v21, v41 row_shl:4 row_mask:0xf bank_mask:0xf
v_fmac_f32_dpp v26, v21, v42 row_shl:4 row_mask:0xf bank_mask:0xf
v_fmac_f32_dpp v27, v21, v43 row_shl:4 row_mask:0xf bank_mask:0xf
v_mov_b32 v18, v17
v_fmac_f32_dpp v24, v22, v44 row_shl:4 row_mask:0xf bank_mask:0xf
v_fmac_f32_dpp v25, v22, v45 row_shl:4 row_mask:0xf bank_mask:0xf
v_fmac_f32_dpp v26, v22, v46 row_shl:4 row_mask:0xf bank_mask:0xf
v_fmac_f32_dpp v27, v22, v47 row_shl:4 row_mask:0xf bank_mask:0xf
v_permlane16_swap_b32 v17, v18
v_add_f32 v17, v17, v18
v_fmac_f32_dpp v24, v23, v48 row_shl:4 row_mask:0xf bank_mask:0xf
v_fmac_f32_dpp v25, v23, v49 row_shl:4 row_mask:0xf bank_mask:0xf
v_fmac_f32_dpp v26, v23, v50 row_shl:4 row_mask:0xf bank_mask:0xf
v_fmac_f32_dpp v27, v23, v51 row_shl:4 row_mask:0xf bank_mask:0xf
v_rcp_f32 v17, v17
v_add_f32_dpp v24, v24, v24 row_ror:8 row_mask:0xf bank_mask:0xf
v_add_f32_dpp v25, v25, v25 row_ror:8 row_mask:0xf bank_mask:0xf
v_add_f32_dpp v26, v26, v26 row_ror:8 row_mask:0xf bank_mask:0xf
v_add_f32_dpp v27, v27, v27 row_ror:8 row_mask:0xf bank_mask:0xf
v_permlane16_swap_b32 v24, v25
s_nop 0
v_permlane16_swap_b32 v26, v27
v_add_f32 v24, v24, v25
v_add_f32 v26, v26, v27
s_nop 0
v_mul_f32_dpp v24, v17, v24 row_shl:4 row_mask:0xf bank_mask:0xf
v_mul_f32_dpp v26, v17, v26 row_shl:4 row_mask:0xf bank_mask:0xf
v_cvt_pk_bf16_f32 v24, v24, v24
v_cvt_pk_bf16_f32 v26, v26, v26
ds_bpermute_b32 v20, v6, v24
ds_bpermute_b32 v21, v7, v24
ds_bpermute_b32 v22, v6, v26
ds_bpermute_b32 v23, v7, v26
s_waitcnt lgkmcnt(3)
v_and_b32 v68, v20, v8
v_and_b32 v69, v20, v9
v_and_b32 v70, v20, v10
v_and_b32 v71, v20, v11
s_nop 1
v_mfma_f32_16x16x32_bf16 v[12:15], v[68:71], v[100:103], 0
s_waitcnt lgkmcnt(2)
v_and_b32 v72, v21, v8
v_and_b32 v73, v21, v9
v_and_b32 v74, v21, v10
v_and_b32 v75, v21, v11
s_nop 1
v_mfma_f32_16x16x32_bf16 v[12:15], v[72:75], v[104:107], v[12:15]
s_waitcnt lgkmcnt(1)
v_and_b32 v76, v22, v8
v_and_b32 v77, v22, v9
v_and_b32 v78, v22, v10
v_and_b32 v79, v22, v11
s_nop 1
v_mfma_f32_16x16x32_bf16 v[12:15], v[76:79], v[108:111], v[12:15]
s_waitcnt lgkmcnt(0)
v_and_b32 v80, v23, v8
v_and_b32 v81, v23, v9
v_and_b32 v82, v23, v10
v_and_b32 v83, v23, v11
s_nop 1
v_mfma_f32_16x16x32_bf16 v[12:15], v[80:83], v[112:115], v[12:15]
s_nop 7
v_and_or_b32 v16, v12, v33, s64
v_and_or_b32 v17, v13, v33, s65
v_and_or_b32 v18, v14, v33, s66
v_and_or_b32 v19, v15, v33, s67
s_mov_b64 s[74:75], exec
s_mov_b64 exec, s[46:47]
buffer_store_dwordx4 v[16:19], v5, s[36:39], s99 offen sc1
s_mov_b64 exec, s[74:75]
v_mov_b32 v2, 0
v_mov_b32 v3, 1
s_mov_b64 s[96:97], exec
s_mov_b64 exec, 1
ds_add_u32 v2, v3 offset:12
s_mov_b64 exec, s[96:97]
s_setprio 0
s_branch L_aux_done
L_aux:
s_cmp_eq_u32 s3, 3
s_cbranch_scc0 L_ygather
s_cmp_eq_u32 s99, 1
s_cbranch_scc0 L_aux_done
v_lshrrev_b32 v6, 5, v0
v_mul_u32_u24 v6, 14, v6
v_bfe_u32 v7, v0, 2, 2
v_add_u32 v6, v6, v7
v_mul_u32_u24 v4, 32896, v6
v_and_b32 v6, 3, v0
v_lshlrev_b32 v6, 5, v6
v_bfe_u32 v7, v0, 4, 1
v_lshlrev_b32 v7, 4, v7
v_add3_u32 v4, v4, v6, v7
s_lshr_b32 s74, s2, 1
s_lshl_b32 s74, s74, 7
s_add_u32 s74, s74, 2359296
buffer_store_dwordx4 v[100:103], v4, s[36:39], s74 offen sc1
s_add_u32 s74, s74, 131584
buffer_store_dwordx4 v[104:107], v4, s[36:39], s74 offen sc1
s_add_u32 s74, s74, 131584
buffer_store_dwordx4 v[108:111], v4, s[36:39], s74 offen sc1
s_add_u32 s74, s74, 131584
v_and_b32 v5, 15, v0
v_cmp_gt_u32 vcc, 8, v5
s_nop 0
s_and_saveexec_b64 s[96:97], vcc
buffer_store_dwordx4 v[112:115], v4, s[36:39], s74 offen sc1
s_mov_b64 exec, s[96:97]
s_branch L_aux_done
L_ygather:
s_cmp_lt_u32 s2, 28
s_cbranch_scc0 L_exit
s_mov_b32 s75, s3
s_sub_u32 s74, s3, 5
s_cmp_ge_u32 s3, 8
s_cselect_b32 s75, s74, s75
s_mul_i32 s74, s2, 32896
s_lshl_b32 s96, s75, 11
s_add_u32 s74, s74, s96
s_add_u32 s74, s74, 2359296
v_lshlrev_b32 v4, 4, v0
s_mov_b32 s98, 0
v_and_b32 v5, 7, v0
v_lshlrev_b32 v5, 4, v5
v_lshrrev_b32 v6, 5, v0
v_lshlrev_b32 v6, 3, v6
v_add_u32 v5, v5, v6
v_bfe_u32 v6, v0, 4, 1
v_lshlrev_b32 v6, 2, v6
v_add_u32 v5, v5, v6
s_lshl_b32 s75, s75, 7
v_add_u32 v5, s75, v5
v_mov_b32 v2, 0
s_mov_b32 s97, 0
L_ypw:
ds_read_b32 v3, v2 offset:8
s_add_u32 s97, s97, 1
s_waitcnt lgkmcnt(0)
v_cmp_le_u32 vcc, 4, v3
s_cbranch_vccnz L_ypw_ok
s_sleep 2
s_cmp_gt_u32 s97, 1600000
s_cbranch_scc0 L_ypw
L_ypw_ok:
s_sleep 32
L_ypoll:
buffer_load_dwordx4 v[36:39], v4, s[36:39], s74 offen offset:0 sc1
buffer_load_dwordx4 v[40:43], v4, s[36:39], s74 offen offset:1024 sc1
s_add_u32 s98, s98, 1
s_waitcnt vmcnt(0)
v_xor_b32 v36, s64, v36
v_xor_b32 v37, s65, v37
v_xor_b32 v38, s66, v38
v_xor_b32 v39, s67, v39
v_xor_b32 v40, s64, v40
v_xor_b32 v41, s65, v41
v_xor_b32 v42, s66, v42
v_xor_b32 v43, s67, v43
v_or3_b32 v16, v36, v37, v38
v_or3_b32 v16, v16, v39, v40
v_or3_b32 v16, v16, v41, v42
v_or_b32 v16, v16, v43
v_and_b32 v16, 0xfff, v16
v_cmp_ne_u32 vcc, 0, v16
s_cbranch_vccz L_yok
s_sleep 16
s_cmp_gt_u32 s98, 200000
s_cbranch_scc0 L_ypoll
L_yok:
v_add_f32 v36, v36, v40
v_add_f32 v37, v37, v41
v_add_f32 v38, v38, v42
v_add_f32 v39, v39, v43
v_add_f32_dpp v36, v36, v36 row_ror:8 row_mask:0xf bank_mask:0xf
v_add_f32_dpp v37, v37, v37 row_ror:8 row_mask:0xf bank_mask:0xf
v_add_f32_dpp v38, v38, v38 row_ror:8 row_mask:0xf bank_mask:0xf
v_add_f32_dpp v39, v39, v39 row_ror:8 row_mask:0xf bank_mask:0xf
v_permlane16_swap_b32 v36, v37
s_nop 0
v_permlane16_swap_b32 v38, v39
v_add_f32 v36, v36, v37
v_add_f32 v38, v38, v39
s_nop 1
v_permlane32_swap_b32 v36, v38
v_add_f32 v36, v36, v38
v_and_b32 v6, 8, v0
v_cmp_eq_u32 vcc, 0, v6
s_nop 0
s_and_saveexec_b64 s[74:75], vcc
ds_write_b32 v5, v36 offset:5952
s_mov_b64 exec, s[74:75]
s_waitcnt lgkmcnt(0)
v_mov_b32 v2, 0
v_mov_b32 v3, 1
s_mov_b64 s[96:97], exec
s_mov_b64 exec, 1
ds_add_u32 v2, v3 offset:4
s_mov_b64 exec, s[96:97]
s_cmp_eq_u32 s3, 0
s_cbranch_scc0 L_final
s_mul_hi_u32 s74, s2, 0x12492493
s_mul_i32 s75, s74, 14
s_sub_u32 s75, s2, s75
s_mul_i32 s74, s74, 896
s_lshl_b32 s75, s75, 6
s_add_u32 s99, s74, s75
v_and_b32 v50, 31, v0
v_lshlrev_b32 v51, 1, v50
buffer_load_ushort v52, v51, s[52:55], s99 offen
v_mov_b32 v2, 0
s_mov_b32 s97, 0
L_ywait:
ds_read_b32 v3, v2 offset:4
s_add_u32 s97, s97, 1
s_waitcnt lgkmcnt(0)
v_cmp_le_u32 vcc, 7, v3
s_cbranch_vccnz L_ywait_ok
s_cmp_gt_u32 s97, 1600000
s_cbranch_scc0 L_ywait
L_ywait_ok:
v_lshlrev_b32 v53, 2, v50
ds_read_b32 v36, v53 offset:5952
ds_read_b32 v37, v53 offset:6080
ds_read_b32 v38, v53 offset:6208
ds_read_b32 v39, v53 offset:6336
ds_read_b32 v40, v53 offset:6464
ds_read_b32 v41, v53 offset:6592
ds_read_b32 v42, v53 offset:6720
s_waitcnt lgkmcnt(0)
v_add_f32 v36, v36, v37
v_add_f32 v38, v38, v39
v_add_f32 v40, v40, v41
v_add_f32 v36, v36, v42
v_add_f32 v36, v36, v38
v_add_f32 v36, v36, v40
v_cvt_pk_bf16_f32 v36, v36, v36
v_and_b32 v36, 0xffff0000, v36
v_mul_f32 v37, 0xbfb8aa3b, v36
v_exp_f32 v37, v37
s_nop 0
v_add_f32 v37, 1.0, v37
v_rcp_f32 v37, v37
s_nop 0
v_mul_f32 v37, v36, v37
v_cvt_pk_bf16_f32 v37, v37, v37
v_and_b32 v54, 0xffff0000, v37
s_waitcnt vmcnt(0)
v_lshlrev_b32 v52, 16, v52
v_lshrrev_b32 v55, 5, v0
v_lshlrev_b32 v55, 10, v55
v_add_u32 v55, v55, v53
s_branch L_final
L_aux_done:
s_cmp_lt_u32 s2, 28
s_cbranch_scc0 L_exit
L_final:
s_mul_i32 s74, s2, 32896
s_lshl_b32 s75, s3, 11
s_add_u32 s74, s74, s75
s_add_u32 s74, s74, 1376256
v_lshlrev_b32 v4, 4, v0
s_mov_b32 s98, 0
v_and_b32 v5, 7, v0
v_lshlrev_b32 v5, 4, v5
v_lshrrev_b32 v6, 5, v0
v_lshlrev_b32 v6, 3, v6
v_add_u32 v5, v5, v6
v_bfe_u32 v6, v0, 4, 1
v_lshlrev_b32 v6, 2, v6
v_add_u32 v5, v5, v6
s_lshl_b32 s75, s3, 7
v_add_u32 v5, s75, v5
v_and_b32 v6, 8, v0
v_cmp_eq_u32 s[46:47], 0, v6
v_mov_b32 v2, 0
s_mov_b32 s97, 0
L_p2w:
ds_read_b32 v3, v2 offset:12
s_add_u32 s97, s97, 1
s_waitcnt lgkmcnt(0)
v_cmp_le_u32 vcc, 4, v3
s_cbranch_vccnz L_p2w_ok
s_sleep 1
s_cmp_gt_u32 s97, 1600000
s_cbranch_scc0 L_p2w
L_p2w_ok:
L_fpoll:
buffer_load_dwordx4 v[36:39], v4, s[36:39], s74 offen offset:0 sc1
buffer_load_dwordx4 v[40:43], v4, s[36:39], s74 offen offset:1024 sc1
s_add_u32 s98, s98, 1
s_waitcnt vmcnt(0)
v_xor_b32 v36, s64, v36
v_xor_b32 v37, s65, v37
v_xor_b32 v38, s66, v38
v_xor_b32 v39, s67, v39
v_xor_b32 v40, s64, v40
v_xor_b32 v41, s65, v41
v_xor_b32 v42, s66, v42
v_xor_b32 v43, s67, v43
v_or3_b32 v16, v36, v37, v38
v_or3_b32 v16, v16, v39, v40
v_or3_b32 v16, v16, v41, v42
v_or_b32 v16, v16, v43
v_and_b32 v16, 0xfff, v16
v_cmp_ne_u32 vcc, 0, v16
s_cbranch_vccz L_fok
s_cmp_gt_u32 s98, 200000
s_cbranch_scc0 L_fpoll
L_fok:
v_add_f32 v36, v36, v40
v_add_f32 v37, v37, v41
v_add_f32 v38, v38, v42
v_add_f32 v39, v39, v43
v_add_f32_dpp v36, v36, v36 row_ror:8 row_mask:0xf bank_mask:0xf
v_add_f32_dpp v37, v37, v37 row_ror:8 row_mask:0xf bank_mask:0xf
v_add_f32_dpp v38, v38, v38 row_ror:8 row_mask:0xf bank_mask:0xf
v_add_f32_dpp v39, v39, v39 row_ror:8 row_mask:0xf bank_mask:0xf
v_permlane16_swap_b32 v36, v37
s_nop 0
v_permlane16_swap_b32 v38, v39
v_add_f32 v36, v36, v37
v_add_f32 v38, v38, v39
s_nop 1
v_permlane32_swap_b32 v36, v38
v_add_f32 v36, v36, v38
s_mov_b64 s[74:75], exec
s_mov_b64 exec, s[46:47]
ds_write_b32 v5, v36 offset:3904
s_mov_b64 exec, s[74:75]
s_waitcnt lgkmcnt(0)
s_barrier
s_cmp_eq_u32 s3, 0
s_cbranch_scc1 L_epi
s_cmp_eq_u32 s3, 1
s_cbranch_scc0 L_exit
s_cmp_eq_u32 s2, 0
s_cbranch_scc0 L_exit
s_mov_b64 exec, 1
v_mov_b32 v4, s68
v_mov_b32 v5, s69
v_mov_b32 v6, 0
buffer_store_dwordx2 v[4:5], v6, s[36:39], 0 offen
s_branch L_exit
L_epi:
ds_read_b32 v36, v55 offset:3904
ds_read_b32 v37, v55 offset:4032
ds_read_b32 v38, v55 offset:4160
ds_read_b32 v39, v55 offset:4288
ds_read_b32 v40, v55 offset:4416
ds_read_b32 v41, v55 offset:4544
ds_read_b32 v42, v55 offset:4672
ds_read_b32 v43, v55 offset:4800
s_waitcnt lgkmcnt(4)
v_add_f32 v36, v36, v37
v_add_f32 v38, v38, v39
s_waitcnt lgkmcnt(0)
v_add_f32 v40, v40, v41
v_add_f32 v42, v42, v43
v_add_f32 v36, v36, v38
v_add_f32 v40, v40, v42
v_add_f32 v36, v36, v40
v_mov_b32 v37, v36
s_nop 1
v_permlane32_swap_b32 v36, v37
v_add_f32 v36, v36, v37
v_cvt_pk_bf16_f32 v36, v36, v36
v_and_b32 v36, 0xffff0000, v36
v_mul_f32 v36, v36, v54
v_cvt_pk_bf16_f32 v36, v36, v36
v_and_b32 v36, 0xffff0000, v36
v_add_f32 v36, v52, v36
v_cvt_pk_bf16_f32 v36, v36, v36
s_mov_b64 exec, s[72:73]
buffer_store_short v36, v51, s[56:59], s99 offen
s_branch L_exit
L_ffn2:
s_waitcnt lgkmcnt(0)
s_mov_b32 s48, s20
s_mov_b32 s49, s21
s_mov_b32 s50, 0x188000
s_mov_b32 s51, 0x20000
s_lshr_b32 s75, s2, 1
s_mul_i32 s74, s75, 14336
v_lshrrev_b32 v6, 2, v0
v_mul_u32_u24 v6, 7168, v6
v_and_b32 v5, 3, v0
v_lshlrev_b32 v5, 4, v5
v_add_u32 v6, v6, v5
s_lshl_b32 s75, s75, 6
s_add_u32 s75, s75, 135168
s_mov_b32 s98, 0
buffer_load_dwordx4 v[100:103], v6, s[36:39], s75 offen sc1
v_lshrrev_b32 v4, 4, v0
v_mul_u32_u24 v4, 3584, v4
v_and_b32 v5, 15, v0
v_lshlrev_b32 v5, 4, v5
v_add_u32 v4, v4, v5
buffer_load_dwordx4 v[36:39], v4, s[48:51], s74 offen offset:0 nt
buffer_load_dwordx4 v[40:43], v4, s[48:51], s74 offen offset:256 nt
buffer_load_dwordx4 v[44:47], v4, s[48:51], s74 offen offset:512 nt
buffer_load_dwordx4 v[48:51], v4, s[48:51], s74 offen offset:768 nt
buffer_load_dwordx4 v[52:55], v4, s[48:51], s74 offen offset:896 nt
buffer_load_dwordx4 v[56:59], v4, s[48:51], s74 offen offset:1152 nt
buffer_load_dwordx4 v[60:63], v4, s[48:51], s74 offen offset:1408 nt
buffer_load_dwordx4 v[64:67], v4, s[48:51], s74 offen offset:1664 nt
buffer_load_dwordx4 v[68:71], v4, s[48:51], s74 offen offset:1792 nt
buffer_load_dwordx4 v[72:75], v4, s[48:51], s74 offen offset:2048 nt
buffer_load_dwordx4 v[76:79], v4, s[48:51], s74 offen offset:2304 nt
buffer_load_dwordx4 v[80:83], v4, s[48:51], s74 offen offset:2560 nt
buffer_load_dwordx4 v[84:87], v4, s[48:51], s74 offen offset:2688 nt
buffer_load_dwordx4 v[88:91], v4, s[48:51], s74 offen offset:2944 nt
buffer_load_dwordx4 v[92:95], v4, s[48:51], s74 offen offset:3200 nt
buffer_load_dwordx4 v[96:99], v4, s[48:51], s74 offen offset:3456 nt
s_waitcnt vmcnt(16)
s_branch L_fchk
L_fpoll2:
s_sleep 16
buffer_load_dwordx4 v[100:103], v6, s[36:39], s75 offen sc1
s_waitcnt vmcnt(0)
L_fchk:
s_add_u32 s98, s98, 1
v_xor_b32 v100, s64, v100
v_xor_b32 v101, s65, v101
v_xor_b32 v102, s66, v102
v_xor_b32 v103, s67, v103
v_or3_b32 v16, v100, v101, v102
v_or_b32 v16, v16, v103
v_and_b32 v16, 0xfff, v16
v_cmp_ne_u32 vcc, 0, v16
s_cbranch_vccz L_fgot
s_cmp_gt_u32 s98, 200000
s_cbranch_scc0 L_fpoll2
L_fgot:
v_add_f32_dpp v100, v100, v100 row_ror:8 row_mask:0xf bank_mask:0xf
v_add_f32_dpp v101, v101, v101 row_ror:8 row_mask:0xf bank_mask:0xf
v_add_f32_dpp v102, v102, v102 row_ror:8 row_mask:0xf bank_mask:0xf
v_add_f32_dpp v103, v103, v103 row_ror:8 row_mask:0xf bank_mask:0xf
v_mov_b32 v104, v100
v_mov_b32 v105, v101
v_mov_b32 v106, v102
v_mov_b32 v107, v103
v_permlane16_swap_b32 v100, v104
v_permlane16_swap_b32 v101, v105
v_permlane16_swap_b32 v102, v106
v_permlane16_swap_b32 v103, v107
v_add_f32 v100, v100, v104
v_add_f32 v101, v101, v105
v_add_f32 v102, v102, v106
v_add_f32 v103, v103, v107
v_mov_b32 v104, v100
v_mov_b32 v105, v101
v_mov_b32 v106, v102
v_mov_b32 v107, v103
v_permlane32_swap_b32 v100, v104
v_permlane32_swap_b32 v101, v105
v_permlane32_swap_b32 v102, v106
v_permlane32_swap_b32 v103, v107
v_cvt_pk_bf16_f32 v100, v100, v104
v_cvt_pk_bf16_f32 v101, v101, v105
v_cvt_pk_bf16_f32 v102, v102, v106
v_cvt_pk_bf16_f32 v103, v103, v107
v_and_b32 v104, 0xffff0000, v100
v_lshlrev_b32 v100, 16, v100
v_and_b32 v105, 0xffff0000, v101
v_lshlrev_b32 v101, 16, v101
v_and_b32 v106, 0xffff0000, v102
v_lshlrev_b32 v102, 16, v102
v_and_b32 v107, 0xffff0000, v103
v_lshlrev_b32 v103, 16, v103
s_mov_b32 s96, 0x3d372713
s_mov_b32 s97, 0xc0135761
v_mul_f32 v108, v100, v100
v_mul_f32 v109, v101, v101
v_mul_f32 v110, v102, v102
v_mul_f32 v111, v103, v103
v_fma_f32 v108, v108, s96, 1.0
v_fma_f32 v109, v109, s96, 1.0
v_fma_f32 v110, v110, s96, 1.0
v_fma_f32 v111, v111, s96, 1.0
v_mul_f32 v108, v108, v100
v_mul_f32 v109, v109, v101
v_mul_f32 v110, v110, v102
v_mul_f32 v111, v111, v103
v_mul_f32 v108, s97, v108
v_mul_f32 v109, s97, v109
v_mul_f32 v110, s97, v110
v_mul_f32 v111, s97, v111
v_exp_f32 v108, v108
v_exp_f32 v109, v109
v_exp_f32 v110, v110
v_exp_f32 v111, v111
v_add_f32 v108, 1.0, v108
v_add_f32 v109, 1.0, v109
v_add_f32 v110, 1.0, v110
v_add_f32 v111, 1.0, v111
v_rcp_f32 v108, v108
v_rcp_f32 v109, v109
v_rcp_f32 v110, v110
v_rcp_f32 v111, v111
v_mul_f32 v108, v108, v100
v_mul_f32 v109, v109, v101
v_mul_f32 v110, v110, v102
v_mul_f32 v111, v111, v103
v_cvt_pk_bf16_f32 v108, v108, v108
v_cvt_pk_bf16_f32 v109, v109, v109
v_cvt_pk_bf16_f32 v110, v110, v110
v_cvt_pk_bf16_f32 v111, v111, v111
v_and_b32 v108, 0xffff0000, v108
v_and_b32 v109, 0xffff0000, v109
v_and_b32 v110, 0xffff0000, v110
v_and_b32 v111, 0xffff0000, v111
v_mul_f32 v108, v108, v104
v_mul_f32 v109, v109, v105
v_mul_f32 v110, v110, v106
v_mul_f32 v111, v111, v107
v_cvt_pk_bf16_f32 v108, v108, v108
v_cvt_pk_bf16_f32 v109, v109, v109
v_cvt_pk_bf16_f32 v110, v110, v110
v_cvt_pk_bf16_f32 v111, v111, v111
v_lshlrev_b32 v5, 4, v0
v_cmp_gt_u32 vcc, 8, v0
s_nop 0
s_and_saveexec_b64 s[96:97], vcc
ds_write_b128 v5, v[108:111] offset:3008
s_mov_b64 exec, s[96:97]
v_bfe_u32 v5, v0, 3, 1
v_lshlrev_b32 v5, 6, v5
v_lshrrev_b32 v7, 4, v0
v_lshlrev_b32 v7, 4, v7
v_add_u32 v5, v5, v7
s_waitcnt lgkmcnt(0)
ds_read_b128 v[112:115], v5 offset:3008
v_mov_b32 v116, 0xfffff000
s_waitcnt lgkmcnt(0) vmcnt(0)
v_and_b32 v20, v112, v8
v_and_b32 v21, v112, v9
v_and_b32 v22, v112, v10
v_and_b32 v23, v112, v11
v_and_b32 v24, v113, v8
v_and_b32 v25, v113, v9
v_and_b32 v26, v113, v10
v_and_b32 v27, v113, v11
v_and_b32 v28, v114, v8
v_and_b32 v29, v114, v9
v_and_b32 v30, v114, v10
v_and_b32 v31, v114, v11
v_and_b32 v32, v115, v8
v_and_b32 v33, v115, v9
v_and_b32 v34, v115, v10
v_and_b32 v35, v115, v11
v_mfma_f32_16x16x32_bf16 v[12:15], v[20:23], v[36:39], 0
v_mfma_f32_16x16x32_bf16 v[12:15], v[24:27], v[52:55], v[12:15]
v_mfma_f32_16x16x32_bf16 v[12:15], v[28:31], v[68:71], v[12:15]
v_mfma_f32_16x16x32_bf16 v[12:15], v[32:35], v[84:87], v[12:15]
v_mfma_f32_16x16x32_bf16 v[16:19], v[20:23], v[40:43], 0
v_mfma_f32_16x16x32_bf16 v[16:19], v[24:27], v[56:59], v[16:19]
v_mfma_f32_16x16x32_bf16 v[16:19], v[28:31], v[72:75], v[16:19]
v_mfma_f32_16x16x32_bf16 v[16:19], v[32:35], v[88:91], v[16:19]
s_nop 3
v_and_or_b32 v100, v12, v116, s64
v_and_or_b32 v101, v13, v116, s65
v_and_or_b32 v102, v14, v116, s66
v_and_or_b32 v103, v15, v116, s67
v_and_or_b32 v104, v16, v116, s64
v_and_or_b32 v105, v17, v116, s65
v_and_or_b32 v106, v18, v116, s66
v_and_or_b32 v107, v19, v116, s67
v_mfma_f32_16x16x32_bf16 v[12:15], v[20:23], v[44:47], 0
v_mfma_f32_16x16x32_bf16 v[12:15], v[24:27], v[60:63], v[12:15]
v_mfma_f32_16x16x32_bf16 v[12:15], v[28:31], v[76:79], v[12:15]
v_mfma_f32_16x16x32_bf16 v[12:15], v[32:35], v[92:95], v[12:15]
v_mfma_f32_16x16x32_bf16 v[16:19], v[20:23], v[48:51], 0
v_mfma_f32_16x16x32_bf16 v[16:19], v[24:27], v[64:67], v[16:19]
v_mfma_f32_16x16x32_bf16 v[16:19], v[28:31], v[80:83], v[16:19]
v_mfma_f32_16x16x32_bf16 v[16:19], v[32:35], v[96:99], v[16:19]
s_nop 3
v_and_or_b32 v108, v12, v116, s64
v_and_or_b32 v109, v13, v116, s65
v_and_or_b32 v110, v14, v116, s66
v_and_or_b32 v111, v15, v116, s67
v_and_or_b32 v112, v16, v116, s64
v_and_or_b32 v113, v17, v116, s65
v_and_or_b32 v114, v18, v116, s66
v_and_or_b32 v115, v19, v116, s67
s_branch L_ffn2_done
L_exit:
L_end:
s_endpgm
L_codeend:
.section .rodata,"a"
.p2align 6
.amdhsa_kernel recurrent_scan__sliding_block_cached__geglu_ffn__decode_kernel
  .amdhsa_next_free_vgpr 128
  .amdhsa_next_free_sgpr 102
  .amdhsa_accum_offset 128
  .amdhsa_group_segment_fixed_size 0
  .amdhsa_kernarg_size 96
  .amdhsa_user_sgpr_count 2
  .amdhsa_user_sgpr_kernarg_segment_ptr 1
  .amdhsa_system_sgpr_workgroup_id_x 1
.end_amdhsa_kernel
```
